```python
import torch

def _softmax(x, axis=-1):
    return torch.softmax(x, dim=axis)
def _gelu(x):
    return torch.nn.functional.gelu(x, approximate="tanh")
def _silu(x):
    return torch.nn.functional.silu(x)
def _sigmoid(x):
    return torch.sigmoid(x)
def _layernorm(x, axis=-1, eps=1e-5):
    m = x.mean(dim=axis, keepdim=True)
    v = x.var(dim=axis, keepdim=True, unbiased=False)
    return (x - m) / torch.sqrt(v + eps)
def _scatter_add(tgt, idx, src, axis=0):
    return tgt.clone().index_add_(axis, idx, src)
def _segment_sum(src, seg, n):
    out = torch.zeros((n,) + src.shape[1:], dtype=src.dtype)
    return out.index_add_(0, seg, src)
def _pad(x, pw):
    flat = tuple(v for pair in reversed(pw) for v in pair)
    return torch.nn.functional.pad(x, flat)

kernel_name = 'gated_mix__linear_kernel_hedgehog__moe_arch_mod__prompt'

def setup_inputs():

    _w = (lambda a: (lambda t: t.to(torch.bfloat16) if t.is_floating_point() else t)(torch.as_tensor(a)))
    def _A_setup():
        B, S, D, H = 1, 2048, 640, 32
        Dh = D // H
        return {
            "x": _w((lambda *s: torch.randn(*s, dtype=torch.bfloat16) * 0.05)(B, S, D)),
            "wqkv": _w((lambda *s: torch.randn(*s, dtype=torch.bfloat16) * 1.6)(D, 3 * D)),
            "w_phi": _w((lambda *s: torch.randn(*s, dtype=torch.bfloat16) * 1.6)(H, Dh, Dh) * (Dh ** -0.5)),
            "wo": _w((lambda *s: torch.randn(*s, dtype=torch.bfloat16) * 0.1)(D, D)),
        }
    _A_in = _A_setup()

    def _B_setup():
        B, S, D, F, C = 1, 2048, 640, 1536, 2
        return {
            "x": _w((lambda *s: torch.randn(*s, dtype=torch.bfloat16) * 0.05)(B, S, D)),
            "w_r": _w((lambda *s: torch.randn(*s, dtype=torch.bfloat16) * 1.6)(D)),
            "w_gate": _w((lambda *s: torch.randn(*s, dtype=torch.bfloat16) * 0.2)(D, F)),
            "w_up": _w((lambda *s: torch.randn(*s, dtype=torch.bfloat16) * 0.2)(D, F)),
            "w_down": _w((lambda *s: torch.randn(*s, dtype=torch.bfloat16) * 0.2)(F, D)),
        }
    _B_in = _B_setup()

    return {
        "A_x": _A_in["x"],
        "A_wqkv": _A_in["wqkv"],
        "A_w_phi": _A_in["w_phi"],
        "A_wo": _A_in["wo"],
        "B_x": _B_in["x"],
        "B_w_r": _B_in["w_r"],
        "B_w_gate": _B_in["w_gate"],
        "B_w_up": _B_in["w_up"],
        "B_w_down": _B_in["w_down"],
        "gate_w": _w((lambda *s: torch.randn(*s, dtype=torch.bfloat16) * 0.05)(640) * 16.0),
    }

def reference(A_x, A_wqkv, A_w_phi, A_wo, B_x, B_w_r, B_w_gate, B_w_up, B_w_down, gate_w):
    def _A_ref(x, wqkv, w_phi, wo):
        B, S, D = x.shape
        H = 32; Dh = D // H
        qkv = (lambda x, *d: x.permute(*d))((x @ wqkv).reshape(B, S, 3, H, Dh), 2, 0, 3, 1, 4)
        q, k, v = qkv[0], qkv[1], qkv[2]
        pq = torch.einsum("bhsd,hdf->bhsf", q, w_phi)
        pk = torch.einsum("bhsd,hdf->bhsf", k, w_phi)
        phi_q = torch.concatenate([_softmax(pq, axis=-1), _softmax(-pq, axis=-1)], axis=-1)
        phi_k = torch.concatenate([_softmax(pk, axis=-1), _softmax(-pk, axis=-1)], axis=-1)
        kv = torch.einsum("bhsf,bhsd->bhfd", phi_k, v)
        z  = torch.einsum("bhsf->bhf", phi_k)
        num = torch.einsum("bhqf,bhfd->bhqd", phi_q, kv)
        den = torch.einsum("bhqf,bhf->bhq", phi_q, z)[..., None] + 1e-6
        o = num / den
        return (lambda x, *d: x.permute(*d))(o, 0, 2, 1, 3).reshape(B, S, D) @ wo

    def _B_ref(x, w_r, w_gate, w_up, w_down):
        B, S, D = x.shape
        C = 2
        r = x @ w_r
        idx = torch.argsort(-r, axis=-1)[:, :C]
        idx_e = (lambda x, n, axis: torch.repeat_interleave(x, n, dim=axis))(idx.reshape(B, C, 1), D, axis=2)
        x_sel = (lambda x, i, axis: torch.take_along_dim(x, i, dim=axis))(x, idx_e, axis=1)
        g = _silu(x_sel @ w_gate)
        u = x_sel @ w_up
        y = (g * u) @ w_down
        r_sel = _sigmoid((lambda x, i, axis: torch.take_along_dim(x, i, dim=axis))(r, idx, axis=1))
        y = y * r_sel.reshape(B, C, 1)
        b_off = (torch.arange(B) * S).reshape(B, 1)
        flat_idx = (idx + b_off).reshape(B * C)
        zero = (x * 0.0).reshape(B * S, D)
        upd = _scatter_add(zero, flat_idx, y.reshape(B * C, D), axis=0)
        return x + upd.reshape(B, S, D)

    x = A_x
    g = _sigmoid((x * gate_w).sum(-1, keepdims=True))
    a = _A_ref(x, A_wqkv, A_w_phi, A_wo)
    b = _B_ref(x, B_w_r, B_w_gate, B_w_up, B_w_down)
    return g * a + (1 - g) * b
```

```asm
; @launch grid=(256,1,1) block=(512,1,1) lds=158208
.amdgcn_target "amdgcn-amd-amdhsa--gfx950"
.text
.globl gated_mix__linear_kernel_hedgehog__moe_arch_mod__prompt_kernel
.p2align 8
.type gated_mix__linear_kernel_hedgehog__moe_arch_mod__prompt_kernel,@function
gated_mix__linear_kernel_hedgehog__moe_arch_mod__prompt_kernel:
  s_load_dwordx16 s[36:51], s[0:1], 0
  s_load_dwordx8 s[52:59], s[0:1], 64
  s_load_dwordx2 s[60:61], s[0:1], 96
  s_cmp_ge_u32 s2, 256
  s_cbranch_scc1 L_END
  s_getpc_b64 s[28:29]
L_PC:
  v_lshrrev_b32 v1, 6, v0
  v_lshrrev_b32 v2, 5, v0
  s_lshr_b32 s33, s2, 3
  s_lshl_b32 s30, s33, 11
  v_readfirstlane_b32 s3, v1
  v_lshl_add_u32 v2, v2, 7, s30
  v_min_u32 v2, L_CODE_END-L_PC-4, v2
  global_load_dword v255, v2, s[28:29]
  v_and_b32 v0, 63, v0
  s_lshr_b32 s31, s2, 5
  s_lshr_b32 s4, s2, 1
  s_and_b32 s4, s4, 3
  s_lshl_b32 s4, s4, 2
  s_bfe_u32 s30, s2, 0x20003
  s_add_u32 s4, s4, s30
  s_and_b32 s5, s2, 1
  s_lshl_b32 s5, s5, 3
  s_add_u32 s5, s5, s31
  s_cmp_lg_u32 s3, 5
  s_cbranch_scc1 L_NP
  v_lshrrev_b32 v2, 4, v0
  v_lshlrev_b32 v3, 2, v2
  v_sub_u32 v3, v0, v3
  s_mul_i32 s34, s4, 8
  s_and_b32 s34, s34, 2
  v_subrev_u32 v7, s34, v3
  v_and_b32 v7, 15, v7
  v_min_u32 v7, 14, v7
  v_mul_u32_u24 v4, 13108, v7
  v_lshrrev_b32 v4, 16, v4
  v_mul_u32_u24 v4, 1200, v4
  v_lshl_add_u32 v4, v7, 4, v4
  v_mul_u32_u24 v6, 3840, v2
  s_mul_i32 s29, s5, 80
  v_add3_u32 v15, v6, v4, s29
  s_mul_i32 s32, s4, 122880
  s_add_u32 s32, s32, 491520
  s_mov_b32 s10, 2457600
  s_mov_b32 s11, 0x20000
  s_waitcnt lgkmcnt(0)
  s_mov_b32 s8, s38
  s_mov_b32 s9, s39
  buffer_load_dwordx4 v[64:67], v15, s[8:11], s32 offen
  s_add_u32 s28, s32, 15360
  buffer_load_dwordx4 v[68:71], v15, s[8:11], s28 offen
  s_add_u32 s28, s32, 61440
  buffer_load_dwordx4 v[80:83], v15, s[8:11], s28 offen
  s_add_u32 s28, s32, 76800
  buffer_load_dwordx4 v[84:87], v15, s[8:11], s28 offen
  s_lshl_b32 s28, s4, 6
  s_add_u32 s28, s28, 256
  s_load_dwordx16 s[68:83], s[54:55], s28
  s_load_dwordx16 s[84:99], s[46:47], s28
  s_load_dword s62, s[60:61], 0
  s_xor_b32 s28, s34, 2
  v_subrev_u32 v8, s28, v3
  v_and_b32 v8, 15, v8
  v_min_u32 v8, 14, v8
  v_mul_u32_u24 v5, 13108, v8
  v_lshrrev_b32 v5, 16, v5
  v_mul_u32_u24 v5, 1200, v5
  v_lshl_add_u32 v5, v8, 4, v5
  v_add3_u32 v14, v6, v5, s29
  s_add_u32 s28, s32, 30720
  buffer_load_dwordx4 v[72:75], v14, s[8:11], s28 offen
  s_add_u32 s28, s32, 46080
  buffer_load_dwordx4 v[76:79], v14, s[8:11], s28 offen
  s_add_u32 s28, s32, 92160
  buffer_load_dwordx4 v[88:91], v14, s[8:11], s28 offen
  s_add_u32 s28, s32, 107520
  buffer_load_dwordx4 v[92:95], v14, s[8:11], s28 offen
  s_lshl_b32 s29, s33, 6
  v_add_u32 v3, s29, v0
  v_mul_u32_u24 v4, 52429, v3
  v_lshrrev_b32 v4, 18, v4
  v_mul_u32_u24 v4, 640, v4
  v_lshl_add_u32 v3, v3, 7, v4
  s_and_b32 s29, s2, 1
  s_mul_i32 s29, s29, 640
  s_mov_b32 s8, s38
  s_mov_b32 s9, s39
  s_mov_b32 s10, 491520
  buffer_load_dword v45, v3, s[8:11], s29 offen
  v_mul_u32_u24 v6, 1280, v0
  s_and_b32 s59, s2, 6
  s_lshl_b32 s59, s59, 2
  s_and_b32 s32, s33, 7
  s_add_u32 s59, s59, s32
  s_mul_i32 s59, s59, 81920
  s_lshr_b32 s32, s33, 3
  s_lshl_b32 s32, s32, 7
  s_add_u32 s59, s59, s32
  s_mov_b32 s8, s36
  s_mov_b32 s9, s37
  s_mov_b32 s10, 2621440
  buffer_load_dword v42, v6, s[8:11], s59 offen
L_NP:
  s_mov_b32 s35, 8000000
  s_lshl_b32 s7, s4, 4
  s_add_u32 s7, s7, s5
  s_mul_i32 s7, s7, 17536
  s_add_u32 s7, s7, 4096
  s_mov_b32 s100, s31
  s_add_u32 s101, s30, s100
  s_and_b32 s101, s101, 3
  s_cmp_lt_u32 s3, 4
  s_cbranch_scc1 L_COMP
  s_cmp_eq_u32 s3, 6
  s_cbranch_scc1 L_FFN
  s_cmp_eq_u32 s3, 7
  s_cbranch_scc1 L_HELP
  v_lshlrev_b32 v41, 4, v0
  s_cmp_lg_u32 s3, 5
  s_cbranch_scc1 L_LX
  v_add_u32 v40, 4096, v41
  s_mul_i32 s63, s5, 163840
  s_add_u32 s63, s63, 4526080
  s_mul_i32 s29, s4, 8192
  s_add_u32 s29, s29, s63
  s_mov_b32 s16, s60
  s_mov_b32 s17, s61
  s_mov_b32 s18, 7114752
  s_mov_b32 s19, 0x20000
  s_waitcnt lgkmcnt(0)
  s_pack_ll_b32_b16 s28, s68, s84
  v_writelane_b32 v104, s28, 15
  s_pack_hh_b32_b16 s28, s68, s84
  v_writelane_b32 v104, s28, 19
  s_pack_ll_b32_b16 s28, s69, s85
  v_writelane_b32 v104, s28, 39
  s_pack_hh_b32_b16 s28, s69, s85
  v_writelane_b32 v104, s28, 59
  s_pack_ll_b32_b16 s28, s70, s86
  v_writelane_b32 v105, s28, 15
  s_pack_hh_b32_b16 s28, s70, s86
  v_writelane_b32 v105, s28, 19
  s_pack_ll_b32_b16 s28, s71, s87
  v_writelane_b32 v105, s28, 39
  s_pack_hh_b32_b16 s28, s71, s87
  v_writelane_b32 v105, s28, 59
  s_pack_ll_b32_b16 s28, s72, s88
  v_writelane_b32 v106, s28, 1
  s_pack_hh_b32_b16 s28, s72, s88
  v_writelane_b32 v106, s28, 21
  s_pack_ll_b32_b16 s28, s73, s89
  v_writelane_b32 v106, s28, 41
  s_pack_hh_b32_b16 s28, s73, s89
  v_writelane_b32 v106, s28, 61
  s_pack_ll_b32_b16 s28, s74, s90
  v_writelane_b32 v107, s28, 1
  s_pack_hh_b32_b16 s28, s74, s90
  v_writelane_b32 v107, s28, 21
  s_pack_ll_b32_b16 s28, s75, s91
  v_writelane_b32 v107, s28, 41
  s_pack_hh_b32_b16 s28, s75, s91
  v_writelane_b32 v107, s28, 61
  s_pack_ll_b32_b16 s28, s76, s92
  v_writelane_b32 v108, s28, 15
  s_pack_hh_b32_b16 s28, s76, s92
  v_writelane_b32 v108, s28, 19
  s_pack_ll_b32_b16 s28, s77, s93
  v_writelane_b32 v108, s28, 39
  s_pack_hh_b32_b16 s28, s77, s93
  v_writelane_b32 v108, s28, 59
  s_pack_ll_b32_b16 s28, s78, s94
  v_writelane_b32 v109, s28, 15
  s_pack_hh_b32_b16 s28, s78, s94
  v_writelane_b32 v109, s28, 19
  s_pack_ll_b32_b16 s28, s79, s95
  v_writelane_b32 v109, s28, 39
  s_pack_hh_b32_b16 s28, s79, s95
  v_writelane_b32 v109, s28, 59
  s_pack_ll_b32_b16 s28, s80, s96
  v_writelane_b32 v110, s28, 1
  s_pack_hh_b32_b16 s28, s80, s96
  v_writelane_b32 v110, s28, 21
  s_pack_ll_b32_b16 s28, s81, s97
  v_writelane_b32 v110, s28, 41
  s_pack_hh_b32_b16 s28, s81, s97
  v_writelane_b32 v110, s28, 61
  s_pack_ll_b32_b16 s28, s82, s98
  v_writelane_b32 v111, s28, 1
  s_pack_hh_b32_b16 s28, s82, s98
  v_writelane_b32 v111, s28, 21
  s_pack_ll_b32_b16 s28, s83, s99
  v_writelane_b32 v111, s28, 41
  s_pack_hh_b32_b16 s28, s83, s99
  v_writelane_b32 v111, s28, 61
  s_waitcnt vmcnt(2)
  s_mov_b32 exec_lo, 557056
  s_mov_b32 exec_hi, 134217856
  v_mov_b32 v64, v104
  v_mov_b32 v68, v105
  v_mov_b32 v80, v108
  v_mov_b32 v84, v109
  s_mov_b32 exec_lo, 2097154
  s_mov_b32 exec_hi, 536871424
  v_mov_b32 v72, v106
  v_mov_b32 v76, v107
  v_mov_b32 v88, v110
  v_mov_b32 v92, v111
  s_mov_b64 exec, -1
  buffer_store_dwordx4 v[64:67], v41, s[16:19], s29 offen offset:0 sc1
  buffer_store_dwordx4 v[68:71], v41, s[16:19], s29 offen offset:1024 sc1
  buffer_store_dwordx4 v[72:75], v41, s[16:19], s29 offen offset:2048 sc1
  buffer_store_dwordx4 v[76:79], v41, s[16:19], s29 offen offset:3072 sc1
  buffer_store_dwordx4 v[80:83], v40, s[16:19], s29 offen offset:0 sc1
  buffer_store_dwordx4 v[84:87], v40, s[16:19], s29 offen offset:1024 sc1
  buffer_store_dwordx4 v[88:91], v40, s[16:19], s29 offen offset:2048 sc1
  buffer_store_dwordx4 v[92:95], v40, s[16:19], s29 offen offset:3072 sc1
  v_add_u32 v16, 0, v15
  v_add_u32 v17, 14336, v15
  v_add_u32 v18, 28672, v14
  v_add_u32 v19, 43008, v14
  v_add_u32 v20, 61440, v15
  v_add_u32 v21, 75776, v15
  v_add_u32 v22, 90112, v14
  v_add_u32 v23, 104448, v14
  v_add_u32 v24, 122880, v15
  v_add_u32 v25, 137216, v15
  v_add_u32 v26, 151552, v14
  v_add_u32 v27, 165888, v14
  v_add_u32 v28, 184320, v15
  v_add_u32 v29, 198656, v15
  v_add_u32 v30, 212992, v14
  v_add_u32 v31, 227328, v14
  v_mov_b32 v32, 0
  v_mov_b32 v33, 0
  v_mov_b32 v34, 0
  v_mov_b32 v35, 0
  v_mov_b32 v36, 0
  s_mov_b32 s12, s42
  s_mov_b32 s13, s43
  s_mov_b32 s14, 819200
  s_mov_b32 s15, 0x20000
  s_mov_b32 s8, s38
  s_mov_b32 s9, s39
  s_mov_b32 s10, 2457600
  s_mov_b32 s11, 0x20000
  s_mov_b32 s30, 0
  s_mov_b32 s31, 245760
  s_mov_b32 s26, 0xfff77fff
  s_mov_b32 s27, 0xf7ffff7f
  s_mov_b32 s96, 0xffdffffd
  s_mov_b32 s97, 0xdffffdff
  s_barrier
  s_mov_b32 s34, 16384
  s_branch L_LOAD
L_LX:
  v_lshrrev_b32 v2, 3, v0
  v_mul_u32_u24 v2, 1280, v2
  v_lshrrev_b32 v3, 4, v0
  v_and_b32 v4, 7, v0
  v_xor_b32 v3, v3, v4
  v_lshl_add_u32 v16, v3, 4, v2
  v_xor_b32 v3, 64, v16
  v_add_u32 v17, 9216, v3
  v_add_u32 v18, 18432, v16
  v_add_u32 v19, 27648, v3
  v_add_u32 v20, 40960, v16
  v_add_u32 v21, 50176, v3
  v_add_u32 v22, 59392, v16
  v_add_u32 v23, 68608, v3
  v_add_u32 v24, 81920, v16
  v_add_u32 v25, 91136, v3
  v_add_u32 v26, 100352, v16
  v_add_u32 v27, 109568, v3
  v_add_u32 v28, 122880, v16
  v_add_u32 v29, 132096, v3
  v_add_u32 v30, 141312, v16
  v_add_u32 v31, 150528, v3
  s_mul_i32 s30, s4, 163840
  s_mov_b32 s31, 128
  s_mov_b32 s32, 1280
  s_mov_b32 s34, 0
  s_mul_i32 s29, s5, 1600
  s_mov_b32 m0, 135168
  s_waitcnt lgkmcnt(0)
  s_mov_b32 s16, s40
  s_mov_b32 s17, s41
  s_mov_b32 s18, 25600
  s_mov_b32 s19, 0x20000
  s_mov_b32 s8, s36
  s_mov_b32 s9, s37
  s_mov_b32 s10, 2621440
  s_mov_b32 s11, 0x20000
  v_add_u32 v7, 0, v0
  v_mul_u32_u24 v8, 6554, v7
  v_lshrrev_b32 v8, 16, v8
  v_mul_u32_u24 v8, 1120, v8
  v_lshl_add_u32 v32, v7, 4, v8
  v_add_u32 v7, 64, v0
  v_mul_u32_u24 v8, 6554, v7
  v_lshrrev_b32 v8, 16, v8
  v_mul_u32_u24 v8, 1120, v8
  v_lshl_add_u32 v33, v7, 4, v8
  v_subrev_u32 v33, 1024, v33
  v_add_u32 v7, 128, v0
  v_mul_u32_u24 v8, 6554, v7
  v_lshrrev_b32 v8, 16, v8
  v_mul_u32_u24 v8, 1120, v8
  v_lshl_add_u32 v34, v7, 4, v8
  v_subrev_u32 v34, 2048, v34
  v_add_u32 v7, 192, v0
  v_mul_u32_u24 v8, 6554, v7
  v_lshrrev_b32 v8, 16, v8
  v_mul_u32_u24 v8, 1120, v8
  v_lshl_add_u32 v35, v7, 4, v8
  v_subrev_u32 v35, 3072, v35
  v_add_u32 v7, 256, v0
  v_mul_u32_u24 v8, 6554, v7
  v_lshrrev_b32 v8, 16, v8
  v_mul_u32_u24 v8, 1120, v8
  v_lshl_add_u32 v36, v7, 4, v8
  s_mul_i32 s21, s100, 160
  s_sub_u32 s24, s3, 4
  s_mul_i32 s25, s101, 5
  s_add_u32 s25, s25, s24
  s_mul_i32 s23, s24, 5120
  s_mov_b32 s12, s42
  s_mov_b32 s13, s43
  s_mov_b32 s14, 819200
  s_mov_b32 s15, 0x20000
  v_bfe_u32 v7, v0, 4, 1
  v_mul_u32_u24 v7, 20, v7
  v_bfe_u32 v8, v0, 2, 2
  v_add_u32 v7, v7, v8
  v_and_b32 v8, 3, v0
  v_mul_u32_u24 v8, 40, v8
  s_mul_i32 s20, s24, 25600
  v_add_u32 v8, s20, v8
  v_lshrrev_b32 v9, 5, v0
  v_lshl_add_u32 v10, v9, 3, v7
  v_mul_u32_u24 v10, 160, v10
  v_add_u32 v37, v10, v8
  v_mul_u32_u24 v10, 80, v9
  v_add3_u32 v10, v10, v7, 16
  v_mul_u32_u24 v10, 160, v10
  v_add_u32 v38, v10, v8
  v_add_u32 v39, s20, v41
  s_lshl_b32 s22, s4, 1
  s_lshr_b32 s28, s5, 3
  s_add_u32 s22, s22, s28
  s_mul_i32 s22, s22, 81920
  s_add_u32 s22, s22, s21
  s_mov_b64 s[26:27], -1
  s_mov_b64 s[96:97], -1
  s_barrier
L_LOAD:
  s_mov_b64 exec, s[26:27]
  s_add_u32 m0, s34, 65536
  s_nop 0
  buffer_load_dwordx4 v16, s[8:11], s30 offen offset:0 sc1 lds
  buffer_load_dwordx4 v17, s[8:11], s30 offen offset:1024 sc1 lds
  s_mov_b64 exec, s[96:97]
  buffer_load_dwordx4 v18, s[8:11], s30 offen offset:2048 sc1 lds
  buffer_load_dwordx4 v19, s[8:11], s30 offen offset:3072 sc1 lds
  s_mov_b64 exec, s[26:27]
  s_add_u32 m0, s34, 69632
  s_nop 0
  buffer_load_dwordx4 v20, s[8:11], s30 offen offset:0 sc1 lds
  buffer_load_dwordx4 v21, s[8:11], s30 offen offset:1024 sc1 lds
  s_mov_b64 exec, s[96:97]
  buffer_load_dwordx4 v22, s[8:11], s30 offen offset:2048 sc1 lds
  buffer_load_dwordx4 v23, s[8:11], s30 offen offset:3072 sc1 lds
  s_cmp_lg_u32 s3, 5
  s_cbranch_scc1 L_NFL
  s_mov_b64 exec, -1
  s_mul_i32 s62, s62, 0x9E3779B1
  s_add_u32 s62, s62, 0x7F4A7C15
  s_and_b32 s62, s62, -2
  v_mov_b32 v48, s62
  v_mov_b32 v49, s62
  v_mov_b32 v50, s62
  v_mov_b32 v51, s62
  s_add_u32 s28, s7, 17280
  s_mul_i32 s34, s5, 17536
  s_add_u32 s34, s34, 20736
  s_add_u32 s44, s4, 1
  s_and_b32 s44, s44, 15
  s_mul_i32 s44, s44, 280576
  s_add_u32 s44, s44, s34
  s_add_u32 s45, s4, 2
  s_and_b32 s45, s45, 15
  s_mul_i32 s45, s45, 280576
  s_add_u32 s45, s45, s34
  s_add_u32 s46, s4, 3
  s_and_b32 s46, s46, 15
  s_mul_i32 s46, s46, 280576
  s_add_u32 s46, s46, s34
  s_add_u32 s47, s4, 4
  s_and_b32 s47, s47, 15
  s_mul_i32 s47, s47, 280576
  s_add_u32 s47, s47, s34
  s_add_u32 s48, s4, 5
  s_and_b32 s48, s48, 15
  s_mul_i32 s48, s48, 280576
  s_add_u32 s48, s48, s34
  s_add_u32 s49, s4, 6
  s_and_b32 s49, s49, 15
  s_mul_i32 s49, s49, 280576
  s_add_u32 s49, s49, s34
  s_add_u32 s50, s4, 7
  s_and_b32 s50, s50, 15
  s_mul_i32 s50, s50, 280576
  s_add_u32 s50, s50, s34
  s_add_u32 s51, s4, 8
  s_and_b32 s51, s51, 15
  s_mul_i32 s51, s51, 280576
  s_add_u32 s51, s51, s34
  s_add_u32 s52, s4, 9
  s_and_b32 s52, s52, 15
  s_mul_i32 s52, s52, 280576
  s_add_u32 s52, s52, s34
  s_add_u32 s53, s4, 10
  s_and_b32 s53, s53, 15
  s_mul_i32 s53, s53, 280576
  s_add_u32 s53, s53, s34
  s_add_u32 s54, s4, 11
  s_and_b32 s54, s54, 15
  s_mul_i32 s54, s54, 280576
  s_add_u32 s54, s54, s34
  s_add_u32 s55, s4, 12
  s_and_b32 s55, s55, 15
  s_mul_i32 s55, s55, 280576
  s_add_u32 s55, s55, s34
  s_add_u32 s56, s4, 13
  s_and_b32 s56, s56, 15
  s_mul_i32 s56, s56, 280576
  s_add_u32 s56, s56, s34
  s_add_u32 s57, s4, 14
  s_and_b32 s57, s57, 15
  s_mul_i32 s57, s57, 280576
  s_add_u32 s57, s57, s34
  s_add_u32 s58, s4, 15
  s_and_b32 s58, s58, 15
  s_mul_i32 s58, s58, 280576
  s_add_u32 s58, s58, s34
  s_mov_b32 s34, 16384
  s_waitcnt vmcnt(8)
  s_mov_b64 exec, 0xff
  buffer_store_dwordx4 v[48:51], v41, s[16:19], s28 offen sc1
  s_mov_b64 exec, -1
  s_mov_b32 s92, s36
  s_mov_b32 s93, s37
  s_mov_b32 s94, 2621440
  s_mov_b32 s95, 0x20000
  v_mul_u32_u24 v6, 1280, v0
  buffer_load_dword v43, v6, s[92:95], s59 offen offset:512
  s_cmp_ge_u32 s2, 128
  s_cselect_b32 s94, 0, 2621440
  buffer_load_dword v44, v6, s[92:95], s59 offen offset:1024
  v_add_u32 v7, 0, v0
  v_mul_u32_u24 v8, 6554, v7
  v_lshrrev_b32 v8, 16, v8
  v_mul_u32_u24 v8, 1120, v8
  v_lshl_add_u32 v32, v7, 4, v8
  v_add_u32 v7, 64, v0
  v_mul_u32_u24 v8, 6554, v7
  v_lshrrev_b32 v8, 16, v8
  v_mul_u32_u24 v8, 1120, v8
  v_lshl_add_u32 v33, v7, 4, v8
  v_subrev_u32 v33, 1024, v33
  v_add_u32 v7, 128, v0
  v_mul_u32_u24 v8, 6554, v7
  v_lshrrev_b32 v8, 16, v8
  v_mul_u32_u24 v8, 1120, v8
  v_lshl_add_u32 v34, v7, 4, v8
  v_subrev_u32 v34, 2048, v34
  v_add_u32 v7, 192, v0
  v_mul_u32_u24 v8, 6554, v7
  v_lshrrev_b32 v8, 16, v8
  v_mul_u32_u24 v8, 1120, v8
  v_lshl_add_u32 v35, v7, 4, v8
  v_subrev_u32 v35, 3072, v35
  v_add_u32 v7, 256, v0
  v_mul_u32_u24 v8, 6554, v7
  v_lshrrev_b32 v8, 16, v8
  v_mul_u32_u24 v8, 1120, v8
  v_lshl_add_u32 v36, v7, 4, v8
  s_mul_i32 s21, s100, 160
  s_sub_u32 s24, s3, 4
  s_mul_i32 s25, s101, 5
  s_add_u32 s25, s25, s24
  s_mul_i32 s23, s24, 5120
  s_mov_b32 s12, s42
  s_mov_b32 s13, s43
  s_mov_b32 s14, 819200
  s_mov_b32 s15, 0x20000
  v_bfe_u32 v7, v0, 4, 1
  v_mul_u32_u24 v7, 20, v7
  v_bfe_u32 v8, v0, 2, 2
  v_add_u32 v7, v7, v8
  v_and_b32 v8, 3, v0
  v_mul_u32_u24 v8, 40, v8
  s_mul_i32 s20, s24, 25600
  v_add_u32 v8, s20, v8
  v_lshrrev_b32 v9, 5, v0
  v_lshl_add_u32 v10, v9, 3, v7
  v_mul_u32_u24 v10, 160, v10
  v_add_u32 v37, v10, v8
  v_mul_u32_u24 v10, 80, v9
  v_add3_u32 v10, v10, v7, 16
  v_mul_u32_u24 v10, 160, v10
  v_add_u32 v38, v10, v8
  v_add_u32 v39, s20, v41
L_NFL:
  s_mov_b64 exec, s[26:27]
  s_add_u32 m0, s34, 73728
  s_nop 0
  buffer_load_dwordx4 v24, s[8:11], s30 offen offset:0 sc1 lds
  buffer_load_dwordx4 v25, s[8:11], s30 offen offset:1024 sc1 lds
  s_mov_b64 exec, s[96:97]
  buffer_load_dwordx4 v26, s[8:11], s30 offen offset:2048 sc1 lds
  buffer_load_dwordx4 v27, s[8:11], s30 offen offset:3072 sc1 lds
  s_mov_b64 exec, s[26:27]
  s_add_u32 m0, s34, 77824
  s_nop 0
  buffer_load_dwordx4 v28, s[8:11], s30 offen offset:0 sc1 lds
  buffer_load_dwordx4 v29, s[8:11], s30 offen offset:1024 sc1 lds
  s_mov_b64 exec, s[96:97]
  buffer_load_dwordx4 v30, s[8:11], s30 offen offset:2048 sc1 lds
  buffer_load_dwordx4 v31, s[8:11], s30 offen offset:3072 sc1 lds
  s_add_u32 s30, s30, s31
  s_mov_b64 exec, s[26:27]
  s_add_u32 m0, s34, 102400
  s_nop 0
  buffer_load_dwordx4 v16, s[8:11], s30 offen offset:0 sc1 lds
  buffer_load_dwordx4 v17, s[8:11], s30 offen offset:1024 sc1 lds
  s_mov_b64 exec, s[96:97]
  buffer_load_dwordx4 v18, s[8:11], s30 offen offset:2048 sc1 lds
  buffer_load_dwordx4 v19, s[8:11], s30 offen offset:3072 sc1 lds
  s_mov_b64 exec, s[26:27]
  s_add_u32 m0, s34, 106496
  s_nop 0
  buffer_load_dwordx4 v20, s[8:11], s30 offen offset:0 sc1 lds
  buffer_load_dwordx4 v21, s[8:11], s30 offen offset:1024 sc1 lds
  s_mov_b64 exec, s[96:97]
  buffer_load_dwordx4 v22, s[8:11], s30 offen offset:2048 sc1 lds
  buffer_load_dwordx4 v23, s[8:11], s30 offen offset:3072 sc1 lds
  s_mov_b64 exec, s[26:27]
  s_add_u32 m0, s34, 110592
  s_nop 0
  buffer_load_dwordx4 v24, s[8:11], s30 offen offset:0 sc1 lds
  buffer_load_dwordx4 v25, s[8:11], s30 offen offset:1024 sc1 lds
  s_mov_b64 exec, s[96:97]
  buffer_load_dwordx4 v26, s[8:11], s30 offen offset:2048 sc1 lds
  buffer_load_dwordx4 v27, s[8:11], s30 offen offset:3072 sc1 lds
  s_mov_b64 exec, s[26:27]
  s_add_u32 m0, s34, 114688
  s_nop 0
  buffer_load_dwordx4 v28, s[8:11], s30 offen offset:0 sc1 lds
  buffer_load_dwordx4 v29, s[8:11], s30 offen offset:1024 sc1 lds
  s_mov_b64 exec, s[96:97]
  buffer_load_dwordx4 v30, s[8:11], s30 offen offset:2048 sc1 lds
  buffer_load_dwordx4 v31, s[8:11], s30 offen offset:3072 sc1 lds
  s_add_u32 s30, s30, s31
  s_cmp_lg_u32 s3, 5
  s_cbranch_scc1 L_NPI
  s_buffer_load_dword s76, s[16:19], s44 offset:640 glc
  s_buffer_load_dword s77, s[16:19], s45 offset:640 glc
  s_buffer_load_dword s78, s[16:19], s46 offset:640 glc
  s_buffer_load_dword s79, s[16:19], s47 offset:640 glc
  s_buffer_load_dword s80, s[16:19], s48 offset:640 glc
  s_buffer_load_dword s81, s[16:19], s49 offset:640 glc
  s_buffer_load_dword s82, s[16:19], s50 offset:640 glc
  s_buffer_load_dword s83, s[16:19], s51 offset:640 glc
  s_buffer_load_dword s84, s[16:19], s52 offset:640 glc
  s_buffer_load_dword s85, s[16:19], s53 offset:640 glc
  s_buffer_load_dword s86, s[16:19], s54 offset:640 glc
  s_buffer_load_dword s87, s[16:19], s55 offset:640 glc
  s_buffer_load_dword s88, s[16:19], s56 offset:640 glc
  s_buffer_load_dword s89, s[16:19], s57 offset:640 glc
  s_buffer_load_dword s90, s[16:19], s58 offset:640 glc
L_NPI:
  s_waitcnt vmcnt(16)
  s_barrier
  s_cmp_lg_u32 s3, 4
  s_cbranch_scc1 L_NXT
  s_mov_b32 m0, 135168
  s_mul_i32 s29, s5, 1600
  buffer_load_dwordx4 v41, s[16:19], s29 offen lds
  buffer_load_dwordx4 v41, s[16:19], s29 offen offset:1024 lds
  s_mov_b32 m0, 147456
  s_nop 0
  buffer_load_dwordx4 v32, s[8:11], s22 offen offset:0 lds
  buffer_load_dwordx4 v33, s[8:11], s22 offen offset:1024 lds
  buffer_load_dwordx4 v34, s[8:11], s22 offen offset:2048 lds
  buffer_load_dwordx4 v35, s[8:11], s22 offen offset:3072 lds
  s_mov_b32 m0, 151552
  s_nop 0
  buffer_load_dwordx4 v36, s[8:11], s22 offen offset:0 lds
  s_add_u32 s22, s22, 40960
  s_mov_b32 m0, 152576
  s_nop 0
  buffer_load_dwordx4 v32, s[8:11], s22 offen offset:0 lds
  buffer_load_dwordx4 v33, s[8:11], s22 offen offset:1024 lds
  buffer_load_dwordx4 v34, s[8:11], s22 offen offset:2048 lds
  buffer_load_dwordx4 v35, s[8:11], s22 offen offset:3072 lds
  s_mov_b32 m0, 156672
  s_nop 0
  buffer_load_dwordx4 v36, s[8:11], s22 offen offset:0 lds
L_NXT:
  s_cmp_lg_u32 s3, 5
  s_cbranch_scc1 L_GATE
  s_mov_b64 exec, -1
  s_mov_b32 s8, s60
  s_mov_b32 s9, s61
  s_mov_b32 s10, 7114752
  s_mov_b32 s11, 0x20000
  v_add_u32 v16, 0, v41
  v_add_u32 v17, 0, v41
  v_add_u32 v18, 0, v41
  v_add_u32 v19, 0, v41
  v_add_u32 v20, 4096, v41
  v_add_u32 v21, 4096, v41
  v_add_u32 v22, 4096, v41
  v_add_u32 v23, 4096, v41
  v_add_u32 v24, 8192, v41
  v_add_u32 v25, 8192, v41
  v_add_u32 v26, 8192, v41
  v_add_u32 v27, 8192, v41
  v_add_u32 v28, 12288, v41
  v_add_u32 v29, 12288, v41
  v_add_u32 v30, 12288, v41
  v_add_u32 v31, 12288, v41
  s_branch S3
S1:
  s_buffer_load_dword s76, s[16:19], s44 offset:640 glc
  s_buffer_load_dword s77, s[16:19], s45 offset:640 glc
  s_buffer_load_dword s78, s[16:19], s46 offset:640 glc
  s_buffer_load_dword s79, s[16:19], s47 offset:640 glc
  s_buffer_load_dword s80, s[16:19], s48 offset:640 glc
  s_buffer_load_dword s81, s[16:19], s49 offset:640 glc
  s_buffer_load_dword s82, s[16:19], s50 offset:640 glc
  s_buffer_load_dword s83, s[16:19], s51 offset:640 glc
  s_buffer_load_dword s84, s[16:19], s52 offset:640 glc
  s_buffer_load_dword s85, s[16:19], s53 offset:640 glc
  s_buffer_load_dword s86, s[16:19], s54 offset:640 glc
  s_buffer_load_dword s87, s[16:19], s55 offset:640 glc
  s_buffer_load_dword s88, s[16:19], s56 offset:640 glc
  s_buffer_load_dword s89, s[16:19], s57 offset:640 glc
  s_buffer_load_dword s90, s[16:19], s58 offset:640 glc
S3:
  s_sub_u32 s35, s35, 20
  s_waitcnt lgkmcnt(0)
  s_cmp_lt_i32 s35, 0
  s_cbranch_scc1 S2
  s_xor_b32 s34, s76, s62
  s_xor_b32 s77, s77, s62
  s_or_b32 s34, s34, s77
  s_xor_b32 s78, s78, s62
  s_or_b32 s34, s34, s78
  s_xor_b32 s79, s79, s62
  s_or_b32 s34, s34, s79
  s_xor_b32 s80, s80, s62
  s_or_b32 s34, s34, s80
  s_xor_b32 s81, s81, s62
  s_or_b32 s34, s34, s81
  s_xor_b32 s82, s82, s62
  s_or_b32 s34, s34, s82
  s_xor_b32 s83, s83, s62
  s_or_b32 s34, s34, s83
  s_xor_b32 s84, s84, s62
  s_or_b32 s34, s34, s84
  s_xor_b32 s85, s85, s62
  s_or_b32 s34, s34, s85
  s_xor_b32 s86, s86, s62
  s_or_b32 s34, s34, s86
  s_xor_b32 s87, s87, s62
  s_or_b32 s34, s34, s87
  s_xor_b32 s88, s88, s62
  s_or_b32 s34, s34, s88
  s_xor_b32 s89, s89, s62
  s_or_b32 s34, s34, s89
  s_xor_b32 s90, s90, s62
  s_or_b32 s34, s34, s90
  s_cbranch_scc1 S1
S2:
  s_mov_b32 s30, s63
  s_mov_b32 s31, 16384
  s_mov_b32 s34, 16384
L_GATE:
  s_add_u32 m0, s34, 0
  s_nop 0
  buffer_load_dwordx4 v16, s[8:11], s30 offen offset:0 sc1 lds
  buffer_load_dwordx4 v17, s[8:11], s30 offen offset:1024 sc1 lds
  buffer_load_dwordx4 v18, s[8:11], s30 offen offset:2048 sc1 lds
  buffer_load_dwordx4 v19, s[8:11], s30 offen offset:3072 sc1 lds
  s_add_u32 m0, s34, 4096
  s_nop 0
  buffer_load_dwordx4 v20, s[8:11], s30 offen offset:0 sc1 lds
  buffer_load_dwordx4 v21, s[8:11], s30 offen offset:1024 sc1 lds
  buffer_load_dwordx4 v22, s[8:11], s30 offen offset:2048 sc1 lds
  buffer_load_dwordx4 v23, s[8:11], s30 offen offset:3072 sc1 lds
  s_add_u32 m0, s34, 8192
  s_nop 0
  buffer_load_dwordx4 v24, s[8:11], s30 offen offset:0 sc1 lds
  buffer_load_dwordx4 v25, s[8:11], s30 offen offset:1024 sc1 lds
  buffer_load_dwordx4 v26, s[8:11], s30 offen offset:2048 sc1 lds
  buffer_load_dwordx4 v27, s[8:11], s30 offen offset:3072 sc1 lds
  s_add_u32 m0, s34, 12288
  s_nop 0
  buffer_load_dwordx4 v28, s[8:11], s30 offen offset:0 sc1 lds
  buffer_load_dwordx4 v29, s[8:11], s30 offen offset:1024 sc1 lds
  buffer_load_dwordx4 v30, s[8:11], s30 offen offset:2048 sc1 lds
  buffer_load_dwordx4 v31, s[8:11], s30 offen offset:3072 sc1 lds
  s_add_u32 s30, s30, s31
  s_waitcnt vmcnt(16)
  s_barrier
  s_add_u32 m0, s34, 32768
  s_nop 0
  buffer_load_dwordx4 v16, s[8:11], s30 offen offset:0 sc1 lds
  buffer_load_dwordx4 v17, s[8:11], s30 offen offset:1024 sc1 lds
  buffer_load_dwordx4 v18, s[8:11], s30 offen offset:2048 sc1 lds
  buffer_load_dwordx4 v19, s[8:11], s30 offen offset:3072 sc1 lds
  s_add_u32 m0, s34, 36864
  s_nop 0
  buffer_load_dwordx4 v20, s[8:11], s30 offen offset:0 sc1 lds
  buffer_load_dwordx4 v21, s[8:11], s30 offen offset:1024 sc1 lds
  buffer_load_dwordx4 v22, s[8:11], s30 offen offset:2048 sc1 lds
  buffer_load_dwordx4 v23, s[8:11], s30 offen offset:3072 sc1 lds
  s_add_u32 m0, s34, 40960
  s_nop 0
  buffer_load_dwordx4 v24, s[8:11], s30 offen offset:0 sc1 lds
  buffer_load_dwordx4 v25, s[8:11], s30 offen offset:1024 sc1 lds
  buffer_load_dwordx4 v26, s[8:11], s30 offen offset:2048 sc1 lds
  buffer_load_dwordx4 v27, s[8:11], s30 offen offset:3072 sc1 lds
  s_add_u32 m0, s34, 45056
  s_nop 0
  buffer_load_dwordx4 v28, s[8:11], s30 offen offset:0 sc1 lds
  buffer_load_dwordx4 v29, s[8:11], s30 offen offset:1024 sc1 lds
  buffer_load_dwordx4 v30, s[8:11], s30 offen offset:2048 sc1 lds
  buffer_load_dwordx4 v31, s[8:11], s30 offen offset:3072 sc1 lds
  s_add_u32 s30, s30, s31
  s_add_u32 m0, s34, 65536
  s_nop 0
  buffer_load_dwordx4 v16, s[8:11], s30 offen offset:0 sc1 lds
  buffer_load_dwordx4 v17, s[8:11], s30 offen offset:1024 sc1 lds
  buffer_load_dwordx4 v18, s[8:11], s30 offen offset:2048 sc1 lds
  buffer_load_dwordx4 v19, s[8:11], s30 offen offset:3072 sc1 lds
  s_add_u32 m0, s34, 69632
  s_nop 0
  buffer_load_dwordx4 v20, s[8:11], s30 offen offset:0 sc1 lds
  buffer_load_dwordx4 v21, s[8:11], s30 offen offset:1024 sc1 lds
  buffer_load_dwordx4 v22, s[8:11], s30 offen offset:2048 sc1 lds
  buffer_load_dwordx4 v23, s[8:11], s30 offen offset:3072 sc1 lds
  s_waitcnt vmcnt(24)
  s_barrier
  s_add_u32 m0, s34, 73728
  s_nop 0
  buffer_load_dwordx4 v24, s[8:11], s30 offen offset:0 sc1 lds
  buffer_load_dwordx4 v25, s[8:11], s30 offen offset:1024 sc1 lds
  buffer_load_dwordx4 v26, s[8:11], s30 offen offset:2048 sc1 lds
  buffer_load_dwordx4 v27, s[8:11], s30 offen offset:3072 sc1 lds
  s_add_u32 m0, s34, 77824
  s_nop 0
  buffer_load_dwordx4 v28, s[8:11], s30 offen offset:0 sc1 lds
  buffer_load_dwordx4 v29, s[8:11], s30 offen offset:1024 sc1 lds
  buffer_load_dwordx4 v30, s[8:11], s30 offen offset:2048 sc1 lds
  buffer_load_dwordx4 v31, s[8:11], s30 offen offset:3072 sc1 lds
  s_add_u32 s30, s30, s31
  s_add_u32 m0, s34, 102400
  s_nop 0
  buffer_load_dwordx4 v16, s[8:11], s30 offen offset:0 sc1 lds
  buffer_load_dwordx4 v17, s[8:11], s30 offen offset:1024 sc1 lds
  buffer_load_dwordx4 v18, s[8:11], s30 offen offset:2048 sc1 lds
  buffer_load_dwordx4 v19, s[8:11], s30 offen offset:3072 sc1 lds
  s_add_u32 m0, s34, 106496
  s_nop 0
  buffer_load_dwordx4 v20, s[8:11], s30 offen offset:0 sc1 lds
  buffer_load_dwordx4 v21, s[8:11], s30 offen offset:1024 sc1 lds
  buffer_load_dwordx4 v22, s[8:11], s30 offen offset:2048 sc1 lds
  buffer_load_dwordx4 v23, s[8:11], s30 offen offset:3072 sc1 lds
  s_waitcnt vmcnt(24)
  s_barrier
  s_add_u32 m0, s34, 110592
  s_nop 0
  buffer_load_dwordx4 v24, s[8:11], s30 offen offset:0 sc1 lds
  buffer_load_dwordx4 v25, s[8:11], s30 offen offset:1024 sc1 lds
  buffer_load_dwordx4 v26, s[8:11], s30 offen offset:2048 sc1 lds
  buffer_load_dwordx4 v27, s[8:11], s30 offen offset:3072 sc1 lds
  s_add_u32 m0, s34, 114688
  s_nop 0
  buffer_load_dwordx4 v28, s[8:11], s30 offen offset:0 sc1 lds
  buffer_load_dwordx4 v29, s[8:11], s30 offen offset:1024 sc1 lds
  buffer_load_dwordx4 v30, s[8:11], s30 offen offset:2048 sc1 lds
  buffer_load_dwordx4 v31, s[8:11], s30 offen offset:3072 sc1 lds
  s_add_u32 s30, s30, s31
  s_add_u32 m0, s34, 0
  s_nop 0
  buffer_load_dwordx4 v16, s[8:11], s30 offen offset:0 sc1 lds
  buffer_load_dwordx4 v17, s[8:11], s30 offen offset:1024 sc1 lds
  buffer_load_dwordx4 v18, s[8:11], s30 offen offset:2048 sc1 lds
  buffer_load_dwordx4 v19, s[8:11], s30 offen offset:3072 sc1 lds
  s_add_u32 m0, s34, 4096
  s_nop 0
  buffer_load_dwordx4 v20, s[8:11], s30 offen offset:0 sc1 lds
  buffer_load_dwordx4 v21, s[8:11], s30 offen offset:1024 sc1 lds
  buffer_load_dwordx4 v22, s[8:11], s30 offen offset:2048 sc1 lds
  buffer_load_dwordx4 v23, s[8:11], s30 offen offset:3072 sc1 lds
  s_waitcnt vmcnt(24)
  s_barrier
  s_add_u32 m0, s34, 8192
  s_nop 0
  buffer_load_dwordx4 v24, s[8:11], s30 offen offset:0 sc1 lds
  buffer_load_dwordx4 v25, s[8:11], s30 offen offset:1024 sc1 lds
  buffer_load_dwordx4 v26, s[8:11], s30 offen offset:2048 sc1 lds
  buffer_load_dwordx4 v27, s[8:11], s30 offen offset:3072 sc1 lds
  s_add_u32 m0, s34, 12288
  s_nop 0
  buffer_load_dwordx4 v28, s[8:11], s30 offen offset:0 sc1 lds
  buffer_load_dwordx4 v29, s[8:11], s30 offen offset:1024 sc1 lds
  buffer_load_dwordx4 v30, s[8:11], s30 offen offset:2048 sc1 lds
  buffer_load_dwordx4 v31, s[8:11], s30 offen offset:3072 sc1 lds
  s_add_u32 s30, s30, s31
  s_add_u32 m0, s34, 32768
  s_nop 0
  buffer_load_dwordx4 v16, s[8:11], s30 offen offset:0 sc1 lds
  buffer_load_dwordx4 v17, s[8:11], s30 offen offset:1024 sc1 lds
  buffer_load_dwordx4 v18, s[8:11], s30 offen offset:2048 sc1 lds
  buffer_load_dwordx4 v19, s[8:11], s30 offen offset:3072 sc1 lds
  s_add_u32 m0, s34, 36864
  s_nop 0
  buffer_load_dwordx4 v20, s[8:11], s30 offen offset:0 sc1 lds
  buffer_load_dwordx4 v21, s[8:11], s30 offen offset:1024 sc1 lds
  buffer_load_dwordx4 v22, s[8:11], s30 offen offset:2048 sc1 lds
  buffer_load_dwordx4 v23, s[8:11], s30 offen offset:3072 sc1 lds
  s_waitcnt vmcnt(24)
  s_barrier
  s_add_u32 m0, s34, 40960
  s_nop 0
  buffer_load_dwordx4 v24, s[8:11], s30 offen offset:0 sc1 lds
  buffer_load_dwordx4 v25, s[8:11], s30 offen offset:1024 sc1 lds
  buffer_load_dwordx4 v26, s[8:11], s30 offen offset:2048 sc1 lds
  buffer_load_dwordx4 v27, s[8:11], s30 offen offset:3072 sc1 lds
  s_add_u32 m0, s34, 45056
  s_nop 0
  buffer_load_dwordx4 v28, s[8:11], s30 offen offset:0 sc1 lds
  buffer_load_dwordx4 v29, s[8:11], s30 offen offset:1024 sc1 lds
  buffer_load_dwordx4 v30, s[8:11], s30 offen offset:2048 sc1 lds
  buffer_load_dwordx4 v31, s[8:11], s30 offen offset:3072 sc1 lds
  s_add_u32 s30, s30, s31
  s_add_u32 m0, s34, 65536
  s_nop 0
  buffer_load_dwordx4 v16, s[8:11], s30 offen offset:0 sc1 lds
  buffer_load_dwordx4 v17, s[8:11], s30 offen offset:1024 sc1 lds
  buffer_load_dwordx4 v18, s[8:11], s30 offen offset:2048 sc1 lds
  buffer_load_dwordx4 v19, s[8:11], s30 offen offset:3072 sc1 lds
  s_add_u32 m0, s34, 69632
  s_nop 0
  buffer_load_dwordx4 v20, s[8:11], s30 offen offset:0 sc1 lds
  buffer_load_dwordx4 v21, s[8:11], s30 offen offset:1024 sc1 lds
  buffer_load_dwordx4 v22, s[8:11], s30 offen offset:2048 sc1 lds
  buffer_load_dwordx4 v23, s[8:11], s30 offen offset:3072 sc1 lds
  s_waitcnt vmcnt(24)
  s_barrier
  s_add_u32 m0, s34, 73728
  s_nop 0
  buffer_load_dwordx4 v24, s[8:11], s30 offen offset:0 sc1 lds
  buffer_load_dwordx4 v25, s[8:11], s30 offen offset:1024 sc1 lds
  buffer_load_dwordx4 v26, s[8:11], s30 offen offset:2048 sc1 lds
  buffer_load_dwordx4 v27, s[8:11], s30 offen offset:3072 sc1 lds
  s_add_u32 m0, s34, 77824
  s_nop 0
  buffer_load_dwordx4 v28, s[8:11], s30 offen offset:0 sc1 lds
  buffer_load_dwordx4 v29, s[8:11], s30 offen offset:1024 sc1 lds
  buffer_load_dwordx4 v30, s[8:11], s30 offen offset:2048 sc1 lds
  buffer_load_dwordx4 v31, s[8:11], s30 offen offset:3072 sc1 lds
  s_add_u32 s30, s30, s31
  s_add_u32 m0, s34, 102400
  s_nop 0
  buffer_load_dwordx4 v16, s[8:11], s30 offen offset:0 sc1 lds
  buffer_load_dwordx4 v17, s[8:11], s30 offen offset:1024 sc1 lds
  buffer_load_dwordx4 v18, s[8:11], s30 offen offset:2048 sc1 lds
  buffer_load_dwordx4 v19, s[8:11], s30 offen offset:3072 sc1 lds
  s_add_u32 m0, s34, 106496
  s_nop 0
  buffer_load_dwordx4 v20, s[8:11], s30 offen offset:0 sc1 lds
  buffer_load_dwordx4 v21, s[8:11], s30 offen offset:1024 sc1 lds
  buffer_load_dwordx4 v22, s[8:11], s30 offen offset:2048 sc1 lds
  buffer_load_dwordx4 v23, s[8:11], s30 offen offset:3072 sc1 lds
  s_waitcnt vmcnt(24)
  s_barrier
  s_add_u32 m0, s34, 110592
  s_nop 0
  buffer_load_dwordx4 v24, s[8:11], s30 offen offset:0 sc1 lds
  buffer_load_dwordx4 v25, s[8:11], s30 offen offset:1024 sc1 lds
  buffer_load_dwordx4 v26, s[8:11], s30 offen offset:2048 sc1 lds
  buffer_load_dwordx4 v27, s[8:11], s30 offen offset:3072 sc1 lds
  s_add_u32 m0, s34, 114688
  s_nop 0
  buffer_load_dwordx4 v28, s[8:11], s30 offen offset:0 sc1 lds
  buffer_load_dwordx4 v29, s[8:11], s30 offen offset:1024 sc1 lds
  buffer_load_dwordx4 v30, s[8:11], s30 offen offset:2048 sc1 lds
  buffer_load_dwordx4 v31, s[8:11], s30 offen offset:3072 sc1 lds
  s_add_u32 m0, s23, 0
  s_mul_i32 s29, s25, 40960
  s_add_u32 s29, s29, s21
  buffer_load_dwordx4 v32, s[12:15], s29 offen offset:0 lds
  buffer_load_dwordx4 v33, s[12:15], s29 offen offset:1024 lds
  buffer_load_dwordx4 v34, s[12:15], s29 offen offset:2048 lds
  buffer_load_dwordx4 v35, s[12:15], s29 offen offset:3072 lds
  s_add_u32 m0, s23, 4096
  s_nop 0
  buffer_load_dwordx4 v36, s[12:15], s29 offen offset:0 lds
  s_add_u32 s25, s25, 2
  s_cmp_ge_u32 s25, 20
  s_cselect_b32 s29, 20, 0
  s_sub_u32 s25, s25, s29
  s_add_u32 m0, s23, 10240
  s_mul_i32 s29, s25, 40960
  s_add_u32 s29, s29, s21
  buffer_load_dwordx4 v32, s[12:15], s29 offen offset:0 lds
  s_waitcnt vmcnt(22)
  s_barrier
  s_waitcnt vmcnt(6)
  s_barrier
  s_barrier
  s_waitcnt vmcnt(10)
  buffer_load_dwordx4 v33, s[12:15], s29 offen offset:1024 lds
  buffer_load_dwordx4 v34, s[12:15], s29 offen offset:2048 lds
  s_waitcnt vmcnt(10)
  buffer_load_dwordx4 v35, s[12:15], s29 offen offset:3072 lds
  s_add_u32 m0, s23, 14336
  s_nop 0
  buffer_load_dwordx4 v36, s[12:15], s29 offen offset:0 lds
  s_add_u32 s25, s25, 2
  s_cmp_ge_u32 s25, 20
  s_cselect_b32 s29, 20, 0
  s_sub_u32 s25, s25, s29
  s_waitcnt vmcnt(10)
  s_add_u32 m0, s23, 20480
  s_mul_i32 s29, s25, 40960
  s_add_u32 s29, s29, s21
  buffer_load_dwordx4 v32, s[12:15], s29 offen offset:0 lds
  buffer_load_dwordx4 v33, s[12:15], s29 offen offset:1024 lds
  s_waitcnt vmcnt(10)
  buffer_load_dwordx4 v34, s[12:15], s29 offen offset:2048 lds
  buffer_load_dwordx4 v35, s[12:15], s29 offen offset:3072 lds
  s_waitcnt vmcnt(10)
  s_add_u32 m0, s23, 24576
  s_nop 0
  buffer_load_dwordx4 v36, s[12:15], s29 offen offset:0 lds
  s_add_u32 s25, s25, 2
  s_cmp_ge_u32 s25, 20
  s_cselect_b32 s29, 20, 0
  s_sub_u32 s25, s25, s29
  s_add_u32 m0, s23, 30720
  s_mul_i32 s29, s25, 40960
  s_add_u32 s29, s29, s21
  buffer_load_dwordx4 v32, s[12:15], s29 offen offset:0 lds
  s_waitcnt vmcnt(10)
  buffer_load_dwordx4 v33, s[12:15], s29 offen offset:1024 lds
  buffer_load_dwordx4 v34, s[12:15], s29 offen offset:2048 lds
  s_waitcnt vmcnt(10)
  buffer_load_dwordx4 v35, s[12:15], s29 offen offset:3072 lds
  s_add_u32 m0, s23, 34816
  s_nop 0
  buffer_load_dwordx4 v36, s[12:15], s29 offen offset:0 lds
  s_add_u32 s25, s25, 2
  s_cmp_ge_u32 s25, 20
  s_cselect_b32 s29, 20, 0
  s_sub_u32 s25, s25, s29
  s_waitcnt vmcnt(10)
  s_add_u32 m0, s23, 40960
  s_mul_i32 s29, s25, 40960
  s_add_u32 s29, s29, s21
  buffer_load_dwordx4 v32, s[12:15], s29 offen offset:0 lds
  buffer_load_dwordx4 v33, s[12:15], s29 offen offset:1024 lds
  s_waitcnt vmcnt(10)
  buffer_load_dwordx4 v34, s[12:15], s29 offen offset:2048 lds
  buffer_load_dwordx4 v35, s[12:15], s29 offen offset:3072 lds
  s_waitcnt vmcnt(10)
  s_add_u32 m0, s23, 45056
  s_nop 0
  buffer_load_dwordx4 v36, s[12:15], s29 offen offset:0 lds
  s_add_u32 s25, s25, 2
  s_cmp_ge_u32 s25, 20
  s_cselect_b32 s29, 20, 0
  s_sub_u32 s25, s25, s29
  s_add_u32 m0, s23, 51200
  s_mul_i32 s29, s25, 40960
  s_add_u32 s29, s29, s21
  buffer_load_dwordx4 v32, s[12:15], s29 offen offset:0 lds
  s_waitcnt vmcnt(10)
  buffer_load_dwordx4 v33, s[12:15], s29 offen offset:1024 lds
  buffer_load_dwordx4 v34, s[12:15], s29 offen offset:2048 lds
  s_waitcnt vmcnt(10)
  buffer_load_dwordx4 v35, s[12:15], s29 offen offset:3072 lds
  s_add_u32 m0, s23, 55296
  s_nop 0
  buffer_load_dwordx4 v36, s[12:15], s29 offen offset:0 lds
  s_add_u32 s25, s25, 2
  s_cmp_ge_u32 s25, 20
  s_cselect_b32 s29, 20, 0
  s_sub_u32 s25, s25, s29
  s_waitcnt vmcnt(10)
  s_add_u32 m0, s23, 61440
  s_mul_i32 s29, s25, 40960
  s_add_u32 s29, s29, s21
  buffer_load_dwordx4 v32, s[12:15], s29 offen offset:0 lds
  buffer_load_dwordx4 v33, s[12:15], s29 offen offset:1024 lds
  s_waitcnt vmcnt(10)
  buffer_load_dwordx4 v34, s[12:15], s29 offen offset:2048 lds
  buffer_load_dwordx4 v35, s[12:15], s29 offen offset:3072 lds
  s_waitcnt vmcnt(10)
  s_add_u32 m0, s23, 65536
  s_nop 0
  buffer_load_dwordx4 v36, s[12:15], s29 offen offset:0 lds
  s_add_u32 s25, s25, 2
  s_cmp_ge_u32 s25, 20
  s_cselect_b32 s29, 20, 0
  s_sub_u32 s25, s25, s29
  s_add_u32 m0, s23, 71680
  s_mul_i32 s29, s25, 40960
  s_add_u32 s29, s29, s21
  buffer_load_dwordx4 v32, s[12:15], s29 offen offset:0 lds
  s_waitcnt vmcnt(10)
  buffer_load_dwordx4 v33, s[12:15], s29 offen offset:1024 lds
  buffer_load_dwordx4 v34, s[12:15], s29 offen offset:2048 lds
  s_waitcnt vmcnt(10)
  buffer_load_dwordx4 v35, s[12:15], s29 offen offset:3072 lds
  s_add_u32 m0, s23, 75776
  s_nop 0
  buffer_load_dwordx4 v36, s[12:15], s29 offen offset:0 lds
  s_add_u32 s25, s25, 2
  s_cmp_ge_u32 s25, 20
  s_cselect_b32 s29, 20, 0
  s_sub_u32 s25, s25, s29
  s_waitcnt vmcnt(10)
  s_add_u32 m0, s23, 81920
  s_mul_i32 s29, s25, 40960
  s_add_u32 s29, s29, s21
  buffer_load_dwordx4 v32, s[12:15], s29 offen offset:0 lds
  buffer_load_dwordx4 v33, s[12:15], s29 offen offset:1024 lds
  s_waitcnt vmcnt(10)
  buffer_load_dwordx4 v34, s[12:15], s29 offen offset:2048 lds
  buffer_load_dwordx4 v35, s[12:15], s29 offen offset:3072 lds
  s_waitcnt vmcnt(10)
  s_add_u32 m0, s23, 86016
  s_nop 0
  buffer_load_dwordx4 v36, s[12:15], s29 offen offset:0 lds
  s_add_u32 s25, s25, 2
  s_cmp_ge_u32 s25, 20
  s_cselect_b32 s29, 20, 0
  s_sub_u32 s25, s25, s29
  s_add_u32 m0, s23, 92160
  s_mul_i32 s29, s25, 40960
  s_add_u32 s29, s29, s21
  buffer_load_dwordx4 v32, s[12:15], s29 offen offset:0 lds
  s_waitcnt vmcnt(10)
  buffer_load_dwordx4 v33, s[12:15], s29 offen offset:1024 lds
  buffer_load_dwordx4 v34, s[12:15], s29 offen offset:2048 lds
  s_waitcnt vmcnt(10)
  buffer_load_dwordx4 v35, s[12:15], s29 offen offset:3072 lds
  s_add_u32 m0, s23, 96256
  s_nop 0
  buffer_load_dwordx4 v36, s[12:15], s29 offen offset:0 lds
  s_add_u32 s25, s25, 2
  s_cmp_ge_u32 s25, 20
  s_cselect_b32 s29, 20, 0
  s_sub_u32 s25, s25, s29
L_LDONE:
  v_mov_b32 v2, 144384
  v_mov_b32 v3, 1
  s_waitcnt vmcnt(0)
  v_mov_b32 v2, 144384
  v_mov_b32 v3, 1
  s_mov_b64 exec, 1
  ds_add_u32 v2, v3 offset:44
  s_mov_b64 exec, -1
W4:
  s_sleep 1
  ds_read_b32 v4, v2 offset:44
  s_sub_u32 s35, s35, 1
  s_cmp_lt_i32 s35, 0
  s_cbranch_scc1 W5
  s_waitcnt lgkmcnt(0)
  v_readfirstlane_b32 s34, v4
  s_nop 0
  s_cmp_ge_u32 s34, 2
  s_cbranch_scc0 W4
W5:
  ds_read_b64_tr_b16 v[48:49], v37 offset:0
  ds_read_b64_tr_b16 v[50:51], v37 offset:640
  ds_read_b64_tr_b16 v[52:53], v37 offset:8
  ds_read_b64_tr_b16 v[54:55], v37 offset:648
  ds_read_b64_tr_b16 v[56:57], v37 offset:16
  ds_read_b64_tr_b16 v[58:59], v37 offset:656
  ds_read_b64_tr_b16 v[60:61], v37 offset:24
  ds_read_b64_tr_b16 v[62:63], v37 offset:664
  ds_read_b64_tr_b16 v[64:65], v37 offset:32
  ds_read_b64_tr_b16 v[66:67], v37 offset:672
  ds_read_b64_tr_b16 v[68:69], v37 offset:6400
  ds_read_b64_tr_b16 v[70:71], v37 offset:7040
  ds_read_b64_tr_b16 v[72:73], v37 offset:6408
  ds_read_b64_tr_b16 v[74:75], v37 offset:7048
  ds_read_b64_tr_b16 v[76:77], v37 offset:6416
  ds_read_b64_tr_b16 v[78:79], v37 offset:7056
  ds_read_b64_tr_b16 v[80:81], v37 offset:6424
  ds_read_b64_tr_b16 v[82:83], v37 offset:7064
  ds_read_b64_tr_b16 v[84:85], v37 offset:6432
  ds_read_b64_tr_b16 v[86:87], v37 offset:7072
  ds_read_b64_tr_b16 v[88:89], v37 offset:12800
  ds_read_b64_tr_b16 v[90:91], v37 offset:13440
  ds_read_b64_tr_b16 v[92:93], v37 offset:12808
  ds_read_b64_tr_b16 v[94:95], v37 offset:13448
  ds_read_b64_tr_b16 v[96:97], v37 offset:12816
  ds_read_b64_tr_b16 v[98:99], v37 offset:13456
  ds_read_b64_tr_b16 v[100:101], v37 offset:12824
  ds_read_b64_tr_b16 v[102:103], v37 offset:13464
  ds_read_b64_tr_b16 v[104:105], v37 offset:12832
  ds_read_b64_tr_b16 v[106:107], v37 offset:13472
  ds_read_b64_tr_b16 v[108:109], v37 offset:19200
  ds_read_b64_tr_b16 v[110:111], v37 offset:19840
  ds_read_b64_tr_b16 v[112:113], v37 offset:19208
  ds_read_b64_tr_b16 v[114:115], v37 offset:19848
  ds_read_b64_tr_b16 v[116:117], v37 offset:19216
  ds_read_b64_tr_b16 v[118:119], v37 offset:19856
  ds_read_b64_tr_b16 v[120:121], v37 offset:19224
  ds_read_b64_tr_b16 v[122:123], v37 offset:19864
  ds_read_b64_tr_b16 v[124:125], v37 offset:19232
  ds_read_b64_tr_b16 v[126:127], v37 offset:19872
  ds_read_b64_tr_b16 v[128:129], v38 offset:0
  ds_read_b64_tr_b16 v[130:131], v38 offset:6400
  ds_read_b64_tr_b16 v[132:133], v38 offset:8
  ds_read_b64_tr_b16 v[134:135], v38 offset:6408
  ds_read_b64_tr_b16 v[136:137], v38 offset:16
  ds_read_b64_tr_b16 v[138:139], v38 offset:6416
  ds_read_b64_tr_b16 v[140:141], v38 offset:24
  ds_read_b64_tr_b16 v[142:143], v38 offset:6424
  ds_read_b64_tr_b16 v[144:145], v38 offset:32
  ds_read_b64_tr_b16 v[146:147], v38 offset:6432
  s_waitcnt lgkmcnt(0)
  ds_write_b128 v39, v[48:51] offset:0
  ds_write_b128 v39, v[52:55] offset:1024
  ds_write_b128 v39, v[56:59] offset:2048
  ds_write_b128 v39, v[60:63] offset:3072
  ds_write_b128 v39, v[64:67] offset:4096
  ds_write_b128 v39, v[68:71] offset:5120
  ds_write_b128 v39, v[72:75] offset:6144
  ds_write_b128 v39, v[76:79] offset:7168
  ds_write_b128 v39, v[80:83] offset:8192
  ds_write_b128 v39, v[84:87] offset:9216
  ds_write_b128 v39, v[88:91] offset:10240
  ds_write_b128 v39, v[92:95] offset:11264
  ds_write_b128 v39, v[96:99] offset:12288
  ds_write_b128 v39, v[100:103] offset:13312
  ds_write_b128 v39, v[104:107] offset:14336
  ds_write_b128 v39, v[108:111] offset:15360
  ds_write_b128 v39, v[112:115] offset:16384
  ds_write_b128 v39, v[116:119] offset:17408
  ds_write_b128 v39, v[120:123] offset:18432
  ds_write_b128 v39, v[124:127] offset:19456
  ds_write_b128 v39, v[128:131] offset:20480
  ds_write_b128 v39, v[132:135] offset:21504
  ds_write_b128 v39, v[136:139] offset:22528
  ds_write_b128 v39, v[140:143] offset:23552
  ds_write_b128 v39, v[144:147] offset:24576
  v_add_u32 v37, 51200, v37
  v_add_u32 v38, 51200, v38
  v_add_u32 v39, 51200, v39
  v_mov_b32 v2, 144384
  v_mov_b32 v3, 1
  s_mov_b64 exec, 1
  ds_add_u32 v2, v3 offset:44
  s_mov_b64 exec, -1
W6:
  s_sleep 1
  ds_read_b32 v4, v2 offset:44
  s_sub_u32 s35, s35, 1
  s_cmp_lt_i32 s35, 0
  s_cbranch_scc1 W7
  s_waitcnt lgkmcnt(0)
  v_readfirstlane_b32 s34, v4
  s_nop 0
  s_cmp_ge_u32 s34, 4
  s_cbranch_scc0 W6
W7:
  ds_read_b64_tr_b16 v[48:49], v37 offset:0
  ds_read_b64_tr_b16 v[50:51], v37 offset:640
  ds_read_b64_tr_b16 v[52:53], v37 offset:8
  ds_read_b64_tr_b16 v[54:55], v37 offset:648
  ds_read_b64_tr_b16 v[56:57], v37 offset:16
  ds_read_b64_tr_b16 v[58:59], v37 offset:656
  ds_read_b64_tr_b16 v[60:61], v37 offset:24
  ds_read_b64_tr_b16 v[62:63], v37 offset:664
  ds_read_b64_tr_b16 v[64:65], v37 offset:32
  ds_read_b64_tr_b16 v[66:67], v37 offset:672
  ds_read_b64_tr_b16 v[68:69], v37 offset:6400
  ds_read_b64_tr_b16 v[70:71], v37 offset:7040
  ds_read_b64_tr_b16 v[72:73], v37 offset:6408
  ds_read_b64_tr_b16 v[74:75], v37 offset:7048
  ds_read_b64_tr_b16 v[76:77], v37 offset:6416
  ds_read_b64_tr_b16 v[78:79], v37 offset:7056
  ds_read_b64_tr_b16 v[80:81], v37 offset:6424
  ds_read_b64_tr_b16 v[82:83], v37 offset:7064
  ds_read_b64_tr_b16 v[84:85], v37 offset:6432
  ds_read_b64_tr_b16 v[86:87], v37 offset:7072
  ds_read_b64_tr_b16 v[88:89], v37 offset:12800
  ds_read_b64_tr_b16 v[90:91], v37 offset:13440
  ds_read_b64_tr_b16 v[92:93], v37 offset:12808
  ds_read_b64_tr_b16 v[94:95], v37 offset:13448
  ds_read_b64_tr_b16 v[96:97], v37 offset:12816
  ds_read_b64_tr_b16 v[98:99], v37 offset:13456
  ds_read_b64_tr_b16 v[100:101], v37 offset:12824
  ds_read_b64_tr_b16 v[102:103], v37 offset:13464
  ds_read_b64_tr_b16 v[104:105], v37 offset:12832
  ds_read_b64_tr_b16 v[106:107], v37 offset:13472
  ds_read_b64_tr_b16 v[108:109], v37 offset:19200
  ds_read_b64_tr_b16 v[110:111], v37 offset:19840
  ds_read_b64_tr_b16 v[112:113], v37 offset:19208
  ds_read_b64_tr_b16 v[114:115], v37 offset:19848
  ds_read_b64_tr_b16 v[116:117], v37 offset:19216
  ds_read_b64_tr_b16 v[118:119], v37 offset:19856
  ds_read_b64_tr_b16 v[120:121], v37 offset:19224
  ds_read_b64_tr_b16 v[122:123], v37 offset:19864
  ds_read_b64_tr_b16 v[124:125], v37 offset:19232
  ds_read_b64_tr_b16 v[126:127], v37 offset:19872
  ds_read_b64_tr_b16 v[128:129], v38 offset:0
  ds_read_b64_tr_b16 v[130:131], v38 offset:6400
  ds_read_b64_tr_b16 v[132:133], v38 offset:8
  ds_read_b64_tr_b16 v[134:135], v38 offset:6408
  ds_read_b64_tr_b16 v[136:137], v38 offset:16
  ds_read_b64_tr_b16 v[138:139], v38 offset:6416
  ds_read_b64_tr_b16 v[140:141], v38 offset:24
  ds_read_b64_tr_b16 v[142:143], v38 offset:6424
  ds_read_b64_tr_b16 v[144:145], v38 offset:32
  ds_read_b64_tr_b16 v[146:147], v38 offset:6432
  s_waitcnt lgkmcnt(0)
  ds_write_b128 v39, v[48:51] offset:0
  ds_write_b128 v39, v[52:55] offset:1024
  ds_write_b128 v39, v[56:59] offset:2048
  ds_write_b128 v39, v[60:63] offset:3072
  ds_write_b128 v39, v[64:67] offset:4096
  ds_write_b128 v39, v[68:71] offset:5120
  ds_write_b128 v39, v[72:75] offset:6144
  ds_write_b128 v39, v[76:79] offset:7168
  ds_write_b128 v39, v[80:83] offset:8192
  ds_write_b128 v39, v[84:87] offset:9216
  ds_write_b128 v39, v[88:91] offset:10240
  ds_write_b128 v39, v[92:95] offset:11264
  ds_write_b128 v39, v[96:99] offset:12288
  ds_write_b128 v39, v[100:103] offset:13312
  ds_write_b128 v39, v[104:107] offset:14336
  ds_write_b128 v39, v[108:111] offset:15360
  ds_write_b128 v39, v[112:115] offset:16384
  ds_write_b128 v39, v[116:119] offset:17408
  ds_write_b128 v39, v[120:123] offset:18432
  ds_write_b128 v39, v[124:127] offset:19456
  ds_write_b128 v39, v[128:131] offset:20480
  ds_write_b128 v39, v[132:135] offset:21504
  ds_write_b128 v39, v[136:139] offset:22528
  ds_write_b128 v39, v[140:143] offset:23552
  ds_write_b128 v39, v[144:147] offset:24576
  v_add_u32 v37, 51200, v37
  v_add_u32 v38, 51200, v38
  v_add_u32 v39, 51200, v39
  s_mov_b64 exec, 1
  ds_add_u32 v2, v3 offset:40
  s_mov_b64 exec, -1
L_END:
  s_endpgm
L_COMP:
  v_and_b32 v48, 31, v0
  v_lshrrev_b32 v49, 5, v0
  s_lshl_b32 s28, s3, 5
  v_add_u32 v50, s28, v48
  v_lshlrev_b32 v50, 7, v50
  v_lshrrev_b32 v51, 4, v50
  v_add_u32 v12, 143360, v51
  v_bfe_u32 v51, v0, 1, 3
  v_lshrrev_b32 v61, 4, v0
  v_xor_b32 v51, v51, v61
  v_and_b32 v60, 15, v0
  v_add_u32 v60, s28, v60
  v_lshlrev_b32 v60, 7, v60
  v_lshl_add_u32 v2, v51, 4, v60
  v_add_u32 v2, 65536, v2
  v_xor_b32 v3, 64, v2
  v_bfe_u32 v52, v0, 2, 2
  v_and_b32 v53, 3, v0
  v_bfe_u32 v54, v0, 4, 1
  v_lshrrev_b32 v55, 1, v53
  v_lshl_add_u32 v55, v54, 1, v55
  v_and_b32 v56, 1, v0
  v_lshlrev_b32 v57, 3, v55
  v_lshrrev_b32 v58, 1, v53
  v_mul_u32_u24 v58, 5, v58
  v_lshl_add_u32 v59, v61, 3, v52
  v_lshlrev_b32 v59, 8, v59
  v_add_u32 v59, 81920, v59
  v_lshlrev_b32 v62, 2, v54
  v_lshl_add_u32 v62, v52, 3, v62
  v_cmp_eq_u32 vcc, 1, v56
  v_mov_b32 v60, 10
  s_nop 0
  v_cndmask_b32 v60, 12, v60, vcc
  v_add_u32 v60, v60, v58
  v_min_u32 v60, 30, v60
  v_add_u32 v60, v60, v62
  v_and_b32 v60, 31, v60
  v_lshl_add_u32 v4, v60, 3, v59
  v_mov_b32 v60, 11
  v_cndmask_b32 v60, 13, v60, vcc
  v_add_u32 v60, v60, v58
  v_min_u32 v60, 30, v60
  v_add_u32 v60, v60, v62
  v_and_b32 v60, 31, v60
  v_lshl_add_u32 v5, v60, 3, v59
  v_mov_b32 v60, 14
  v_cndmask_b32 v60, 24, v60, vcc
  v_add_u32 v60, v60, v58
  v_min_u32 v60, 30, v60
  v_add_u32 v60, v60, v62
  v_and_b32 v60, 31, v60
  v_lshl_add_u32 v6, v60, 3, v59
  v_mov_b32 v60, 30
  v_cndmask_b32 v60, 4, v60, vcc
  v_add_u32 v60, v60, v58
  v_min_u32 v60, 30, v60
  v_add_u32 v60, v60, v62
  v_and_b32 v60, 31, v60
  v_lshl_add_u32 v7, v60, 3, v59
  v_mov_b32 v60, 2
  v_cndmask_b32 v60, 0, v60, vcc
  v_add_u32 v60, v60, v58
  v_min_u32 v60, 30, v60
  v_add_u32 v60, v60, v62
  v_and_b32 v60, 31, v60
  v_lshl_add_u32 v8, v60, 3, v59
  v_mov_b32 v60, 3
  v_cndmask_b32 v60, 1, v60, vcc
  v_add_u32 v60, v60, v58
  v_min_u32 v60, 30, v60
  v_add_u32 v60, v60, v62
  v_and_b32 v60, 31, v60
  v_lshl_add_u32 v9, v60, 3, v59
  v_mov_b32 v60, 22
  v_cndmask_b32 v60, 20, v60, vcc
  v_add_u32 v60, v60, v58
  v_min_u32 v60, 30, v60
  v_add_u32 v60, v60, v62
  v_and_b32 v60, 31, v60
  v_lshl_add_u32 v10, v60, 3, v59
  v_mov_b32 v60, 23
  v_cndmask_b32 v60, 21, v60, vcc
  v_add_u32 v60, v60, v58
  v_min_u32 v60, 30, v60
  v_add_u32 v60, v60, v62
  v_and_b32 v60, 31, v60
  v_lshl_add_u32 v11, v60, 3, v59
  v_bfe_u32 v60, v0, 2, 1
  v_lshl_add_u32 v60, v60, 1, v56
  v_bfe_u32 v61, v0, 1, 1
  v_lshl_add_u32 v60, v61, 2, v60
  v_lshl_add_u32 v60, v60, 4, v50
  v_lshl_add_u32 v60, v49, 14, v60
  v_add_u32 v18, 102400, v60
  v_xor_b32 v19, 16, v18
  v_xor_b32 v20, 32, v18
  v_xor_b32 v21, 48, v18
  v_xor_b32 v22, 64, v18
  v_xor_b32 v23, 80, v18
  v_xor_b32 v24, 96, v18
  v_xor_b32 v25, 112, v18
  s_lshr_b32 s28, s3, 1
  s_and_b32 s29, s3, 1
  v_and_b32 v60, 1, v52
  v_lshrrev_b32 v61, 1, v52
  v_lshl_add_u32 v60, v61, 2, v60
  v_lshlrev_b32 v60, 1, v60
  v_lshl_add_u32 v61, v49, 3, v52
  v_lshlrev_b32 v61, 7, v61
  s_lshl_b32 s33, s28, 14
  s_add_u32 s33, s33, 102400
  v_add_u32 v61, s33, v61
  s_lshl_b32 s33, s29, 3
  v_lshl_add_u32 v62, v56, 2, v55
  v_add_u32 v62, s33, v62
  v_xor_b32 v62, v62, v60
  v_lshl_add_u32 v26, v62, 3, v61
  v_lshl_add_u32 v62, v54, 2, v53
  v_add_u32 v62, 10, v62
  v_and_b32 v62, 15, v62
  v_xor_b32 v62, v62, v60
  v_lshl_add_u32 v28, v62, 3, v61
  v_add_u32 v27, 512, v26
  v_xor_b32 v27, 32, v27
  v_add_u32 v29, 512, v28
  v_xor_b32 v29, 32, v29
  v_mul_u32_u24 v60, 800, v56
  v_mul_u32_u24 v61, 40, v52
  v_add3_u32 v60, v60, v61, v57
  v_add_u32 v60, 135168, v60
  v_mov_b32 v61, 137216
  v_cmp_eq_u32 vcc, v56, v49
  s_nop 1
  v_cndmask_b32 v30, v61, v60, vcc
  v_lshlrev_b32 v60, 1, v49
  s_cmp_eq_u32 s29, 1
  s_cselect_b32 s33, 0, -1
  v_and_b32 v60, s33, v60
  s_mul_i32 s33, s28, 5
  s_lshl_b32 s34, s29, 2
  s_add_u32 s33, s33, s34
  v_add_u32 v60, s33, v60
  v_mul_u32_u24 v60, 24, v60
  v_add_lshl_u32 v31, v60, v48, 4
  v_mov_b32 v32, 144384
  v_mov_b32 v33, 1
  v_and_b32 v60, 15, v0
  v_lshrrev_b32 v61, 4, v0
  s_mov_b32 s33, 280576
  v_mul_lo_u32 v62, v61, s33
  s_lshl_b32 s33, s3, 4
  v_add_u32 v63, s33, v60
  v_lshl_add_u32 v34, v63, 4, v62
  v_add_u32 v63, 192, v63
  v_min_u32 v63, 239, v63
  v_lshl_add_u32 v35, v63, 4, v62
  v_lshlrev_b32 v62, 4, v56
  v_mov_b32 v63, 0x3f80
  v_lshlrev_b32 v63, v62, v63
  v_lshrrev_b32 v62, 1, v60
  v_cmp_eq_u32 vcc, 0, v62
  s_nop 1
  v_cndmask_b32 v44, 0, v63, vcc
  v_cmp_eq_u32 vcc, 1, v62
  s_nop 1
  v_cndmask_b32 v45, 0, v63, vcc
  v_cmp_eq_u32 vcc, 2, v62
  s_nop 1
  v_cndmask_b32 v46, 0, v63, vcc
  v_cmp_eq_u32 vcc, 3, v62
  s_nop 1
  v_cndmask_b32 v47, 0, v63, vcc
  v_bfe_u32 v62, v0, 3, 2
  v_lshl_add_u32 v62, v62, 2, v53
  v_bfe_u32 v63, v0, 2, 1
  v_mul_u32_u24 v64, 120, v63
  v_add_lshl_u32 v62, v62, v64, 4
  v_add_u32 v62, 139264, v62
  v_mov_b32 v64, 137216
  v_cmp_eq_u32 vcc, v63, v49
  s_nop 1
  v_cndmask_b32 v36, v64, v62, vcc
  s_lshl_b32 s33, s3, 1
  v_add_u32 v62, s33, v54
  v_mul_u32_u24 v62, 1280, v62
  v_lshl_add_u32 v62, v49, 8, v62
  v_lshl_add_u32 v37, v60, 4, v62
  s_cmp_eq_u32 s3, 0
  s_cselect_b32 s96, 1, 0
  s_mov_b32 s97, 0
  s_add_u32 s98, s7, 16639
  s_mov_b32 s24, 3216550459
  s_mov_b32 s25, 3216550459
  s_mov_b32 s26, 1069066811
  s_mov_b32 s27, 1069066811
  s_waitcnt lgkmcnt(0)
  s_mov_b32 s8, s60
  s_mov_b32 s9, s61
  s_mov_b32 s10, 7114752
  s_mov_b32 s11, 0x20000
  s_mov_b32 s16, s56
  s_mov_b32 s17, s57
  s_mov_b32 s18, 2621440
  s_mov_b32 s19, 0x20000
  s_mul_i32 s33, s5, 17536
  s_add_u32 s33, s33, 14336
  s_add_u32 s32, s4, 0
  s_and_b32 s32, s32, 3
  s_mul_i32 s32, s32, 1122304
  s_add_u32 s20, s33, s32
  s_add_u32 s32, s4, 1
  s_and_b32 s32, s32, 3
  s_mul_i32 s32, s32, 1122304
  s_add_u32 s21, s33, s32
  s_add_u32 s32, s4, 2
  s_and_b32 s32, s32, 3
  s_mul_i32 s32, s32, 1122304
  s_add_u32 s22, s33, s32
  s_add_u32 s32, s4, 3
  s_and_b32 s32, s32, 3
  s_mul_i32 s32, s32, 1122304
  s_add_u32 s23, s33, s32
  s_mul_i32 s34, s4, 280576
  s_lshr_b32 s33, s5, 3
  s_lshl_b32 s33, s33, 2
  s_add_u32 s33, s33, s3
  s_lshl_b32 s44, s33, 4
  s_mul_i32 s33, s33, 1280
  s_add_u32 s34, s34, s33
  s_add_u32 s34, s34, 4096
  s_add_u32 s33, s101, 0
  s_and_b32 s33, s33, 3
  s_mul_i32 s33, s33, 70144
  s_add_u32 s40, s34, s33
  s_add_u32 s33, s101, 1
  s_and_b32 s33, s33, 3
  s_mul_i32 s33, s33, 70144
  s_add_u32 s41, s34, s33
  s_add_u32 s33, s101, 2
  s_and_b32 s33, s33, 3
  s_mul_i32 s33, s33, 70144
  s_add_u32 s42, s34, s33
  s_add_u32 s33, s101, 3
  s_and_b32 s33, s33, 3
  s_mul_i32 s33, s33, 70144
  s_add_u32 s43, s34, s33
  s_lshl_b32 s45, s4, 7
  s_add_u32 s45, s45, s44
  s_mul_i32 s45, s45, 1280
  s_mul_i32 s33, s100, 160
  s_add_u32 s45, s45, s33
  s_add_u32 s46, s7, 10240
  s_cmp_eq_u32 s29, 1
  s_cselect_b32 s47, 0, 0xffffff
  s_mul_i32 s48, s3, 2560
  s_add_u32 s48, s48, 147456
  v_lshlrev_b32 v240, 4, v0
  s_mov_b32 s33, 35072
  v_mul_lo_u32 v241, v49, s33
  v_lshl_add_u32 v241, v48, 3, v241
  v_mul_u32_u24 v62, 20, v54
  v_add_u32 v62, v62, v52
  v_mul_u32_u24 v63, 40, v53
  v_lshl_add_u32 v64, v49, 3, v62
  v_mul_u32_u24 v64, 160, v64
  v_add_u32 v242, v64, v63
  v_add_u32 v243, 51200, v242
  v_mul_u32_u24 v64, 80, v49
  v_add3_u32 v64, v64, v62, 16
  v_mul_u32_u24 v64, 160, v64
  v_add_u32 v244, v64, v63
  v_add_u32 v245, 51200, v244
  v_lshlrev_b32 v62, 3, v60
  v_lshl_add_u32 v62, v49, 7, v62
  v_sub_u32 v246, v37, v62
  v_mul_u32_u24 v62, 40, v61
  v_mul_u32_u24 v63, 160, v60
  v_add3_u32 v247, v63, v62, s48
  v_add_u32 v251, s48, v240
  s_lshl_b32 s33, s3, 8
  s_add_u32 s33, s33, 139264
  v_lshlrev_b32 v62, 4, v60
  v_lshl_add_u32 v62, v61, 3, v62
  v_add_u32 v252, s33, v62
  v_add_lshl_u32 v62, v60, s44, 3
  v_add_u32 v253, 143360, v62
  v_add_u32 v62, 0, v0
  v_mul_u32_u24 v63, 6554, v62
  v_lshrrev_b32 v63, 16, v63
  v_mul_u32_u24 v63, 1120, v63
  v_lshl_add_u32 v248, v62, 4, v63
  v_add_u32 v62, 64, v0
  v_mul_u32_u24 v63, 6554, v62
  v_lshrrev_b32 v63, 16, v63
  v_mul_u32_u24 v63, 1120, v63
  v_lshl_add_u32 v249, v62, 4, v63
  v_add_u32 v62, 128, v0
  v_mul_u32_u24 v63, 6554, v62
  v_lshrrev_b32 v63, 16, v63
  v_mul_u32_u24 v63, 1120, v63
  v_lshl_add_u32 v250, v62, 4, v63
  s_barrier
  s_barrier
  ds_read_b64_tr_b16 v[112:113], v4 offset:0
  ds_read_b64_tr_b16 v[114:115], v4 offset:1024
  ds_read_b128 v[144:147], v2 offset:0
  ds_read_b128 v[148:151], v2 offset:2048
  ds_read_b64_tr_b16 v[116:117], v5 offset:0
  ds_read_b64_tr_b16 v[118:119], v5 offset:1024
  ds_read_b64_tr_b16 v[120:121], v6 offset:0
  ds_read_b64_tr_b16 v[122:123], v6 offset:1024
  ds_read_b64_tr_b16 v[124:125], v7 offset:0
  ds_read_b64_tr_b16 v[126:127], v7 offset:1024
  ds_read_b64_tr_b16 v[128:129], v8 offset:0
  ds_read_b64_tr_b16 v[130:131], v8 offset:1024
  ds_read_b64_tr_b16 v[132:133], v9 offset:0
  ds_read_b64_tr_b16 v[134:135], v9 offset:1024
  ds_read_b64_tr_b16 v[136:137], v10 offset:0
  ds_read_b64_tr_b16 v[138:139], v10 offset:1024
  ds_read_b64_tr_b16 v[140:141], v11 offset:0
  ds_read_b64_tr_b16 v[142:143], v11 offset:1024
  s_waitcnt lgkmcnt(15)
  v_mfma_f32_16x16x32_bf16 v[48:51], v[112:115], v[144:147], 0
  ds_read_b64_tr_b16 v[208:209], v4 offset:8192
  ds_read_b64_tr_b16 v[210:211], v4 offset:9216
  s_waitcnt lgkmcnt(15)
  v_mfma_f32_16x16x32_bf16 v[52:55], v[112:115], v[148:151], 0
  ds_read_b128 v[200:203], v3 offset:0
  ds_read_b128 v[204:207], v3 offset:2048
  s_waitcnt lgkmcnt(15)
  v_mfma_f32_16x16x32_bf16 v[56:59], v[116:119], v[144:147], 0
  ds_read_b64_tr_b16 v[212:213], v5 offset:8192
  ds_read_b64_tr_b16 v[214:215], v5 offset:9216
  v_mfma_f32_16x16x32_bf16 v[60:63], v[116:119], v[148:151], 0
  ds_read_b64_tr_b16 v[216:217], v6 offset:8192
  ds_read_b64_tr_b16 v[218:219], v6 offset:9216
  s_waitcnt lgkmcnt(15)
  v_mfma_f32_16x16x32_bf16 v[64:67], v[120:123], v[144:147], 0
  ds_read_b64_tr_b16 v[220:221], v7 offset:8192
  v_mfma_f32_16x16x32_bf16 v[68:71], v[120:123], v[148:151], 0
  ds_read_b64_tr_b16 v[222:223], v7 offset:9216
  s_waitcnt lgkmcnt(15)
  v_mfma_f32_16x16x32_bf16 v[72:75], v[124:127], v[144:147], 0
  ds_read_b64_tr_b16 v[224:225], v8 offset:8192
  v_mfma_f32_16x16x32_bf16 v[76:79], v[124:127], v[148:151], 0
  ds_read_b64_tr_b16 v[226:227], v8 offset:9216
  s_waitcnt lgkmcnt(15)
  v_mfma_f32_16x16x32_bf16 v[80:83], v[128:131], v[144:147], 0
  ds_read_b64_tr_b16 v[228:229], v9 offset:8192
  v_mfma_f32_16x16x32_bf16 v[84:87], v[128:131], v[148:151], 0
  ds_read_b64_tr_b16 v[230:231], v9 offset:9216
  s_waitcnt lgkmcnt(15)
  v_mfma_f32_16x16x32_bf16 v[88:91], v[132:135], v[144:147], 0
  ds_read_b64_tr_b16 v[232:233], v10 offset:8192
  v_mfma_f32_16x16x32_bf16 v[92:95], v[132:135], v[148:151], 0
  ds_read_b64_tr_b16 v[234:235], v10 offset:9216
  s_waitcnt lgkmcnt(15)
  v_mfma_f32_16x16x32_bf16 v[96:99], v[136:139], v[144:147], 0
  ds_read_b64_tr_b16 v[236:237], v11 offset:8192
  v_mfma_f32_16x16x32_bf16 v[100:103], v[136:139], v[148:151], 0
  ds_read_b64_tr_b16 v[238:239], v11 offset:9216
  s_waitcnt lgkmcnt(15)
  v_mfma_f32_16x16x32_bf16 v[104:107], v[140:143], v[144:147], 0
  v_mfma_f32_16x16x32_bf16 v[108:111], v[140:143], v[148:151], 0
  s_waitcnt lgkmcnt(0)
  s_barrier
  v_mfma_f32_16x16x32_bf16 v[48:51], v[208:211], v[200:203], v[48:51]
  ds_read_b64_tr_b16 v[112:113], v4 offset:36864
  ds_read_b64_tr_b16 v[114:115], v4 offset:37888
  v_mfma_f32_16x16x32_bf16 v[52:55], v[208:211], v[204:207], v[52:55]
  ds_read_b128 v[144:147], v2 offset:36864
  ds_read_b128 v[148:151], v2 offset:38912
  v_mfma_f32_16x16x32_bf16 v[56:59], v[212:215], v[200:203], v[56:59]
  ds_read_b64_tr_b16 v[116:117], v5 offset:36864
  ds_read_b64_tr_b16 v[118:119], v5 offset:37888
  v_mfma_f32_16x16x32_bf16 v[60:63], v[212:215], v[204:207], v[60:63]
  ds_read_b64_tr_b16 v[120:121], v6 offset:36864
  ds_read_b64_tr_b16 v[122:123], v6 offset:37888
  v_mfma_f32_16x16x32_bf16 v[64:67], v[216:219], v[200:203], v[64:67]
  ds_read_b64_tr_b16 v[124:125], v7 offset:36864
  v_mfma_f32_16x16x32_bf16 v[68:71], v[216:219], v[204:207], v[68:71]
  ds_read_b64_tr_b16 v[126:127], v7 offset:37888
  v_mfma_f32_16x16x32_bf16 v[72:75], v[220:223], v[200:203], v[72:75]
  ds_read_b64_tr_b16 v[128:129], v8 offset:36864
  v_mfma_f32_16x16x32_bf16 v[76:79], v[220:223], v[204:207], v[76:79]
  ds_read_b64_tr_b16 v[130:131], v8 offset:37888
  v_mfma_f32_16x16x32_bf16 v[80:83], v[224:227], v[200:203], v[80:83]
  ds_read_b64_tr_b16 v[132:133], v9 offset:36864
  v_mfma_f32_16x16x32_bf16 v[84:87], v[224:227], v[204:207], v[84:87]
  ds_read_b64_tr_b16 v[134:135], v9 offset:37888
  v_mfma_f32_16x16x32_bf16 v[88:91], v[228:231], v[200:203], v[88:91]
  ds_read_b64_tr_b16 v[136:137], v10 offset:36864
  v_mfma_f32_16x16x32_bf16 v[92:95], v[228:231], v[204:207], v[92:95]
  ds_read_b64_tr_b16 v[138:139], v10 offset:37888
  v_mfma_f32_16x16x32_bf16 v[96:99], v[232:235], v[200:203], v[96:99]
  ds_read_b64_tr_b16 v[140:141], v11 offset:36864
  v_mfma_f32_16x16x32_bf16 v[100:103], v[232:235], v[204:207], v[100:103]
  ds_read_b64_tr_b16 v[142:143], v11 offset:37888
  v_mfma_f32_16x16x32_bf16 v[104:107], v[236:239], v[200:203], v[104:107]
  v_mfma_f32_16x16x32_bf16 v[108:111], v[236:239], v[204:207], v[108:111]
  s_waitcnt lgkmcnt(15)
  v_mfma_f32_16x16x32_bf16 v[48:51], v[112:115], v[144:147], v[48:51]
  ds_read_b64_tr_b16 v[208:209], v4 offset:45056
  ds_read_b64_tr_b16 v[210:211], v4 offset:46080
  s_waitcnt lgkmcnt(15)
  v_mfma_f32_16x16x32_bf16 v[52:55], v[112:115], v[148:151], v[52:55]
  ds_read_b128 v[200:203], v3 offset:36864
  ds_read_b128 v[204:207], v3 offset:38912
  s_waitcnt lgkmcnt(15)
  v_mfma_f32_16x16x32_bf16 v[56:59], v[116:119], v[144:147], v[56:59]
  ds_read_b64_tr_b16 v[212:213], v5 offset:45056
  ds_read_b64_tr_b16 v[214:215], v5 offset:46080
  v_mfma_f32_16x16x32_bf16 v[60:63], v[116:119], v[148:151], v[60:63]
  ds_read_b64_tr_b16 v[216:217], v6 offset:45056
  ds_read_b64_tr_b16 v[218:219], v6 offset:46080
  s_waitcnt lgkmcnt(15)
  v_mfma_f32_16x16x32_bf16 v[64:67], v[120:123], v[144:147], v[64:67]
  ds_read_b64_tr_b16 v[220:221], v7 offset:45056
  v_mfma_f32_16x16x32_bf16 v[68:71], v[120:123], v[148:151], v[68:71]
  ds_read_b64_tr_b16 v[222:223], v7 offset:46080
  s_waitcnt lgkmcnt(15)
  v_mfma_f32_16x16x32_bf16 v[72:75], v[124:127], v[144:147], v[72:75]
  ds_read_b64_tr_b16 v[224:225], v8 offset:45056
  v_mfma_f32_16x16x32_bf16 v[76:79], v[124:127], v[148:151], v[76:79]
  ds_read_b64_tr_b16 v[226:227], v8 offset:46080
  s_waitcnt lgkmcnt(15)
  v_mfma_f32_16x16x32_bf16 v[80:83], v[128:131], v[144:147], v[80:83]
  ds_read_b64_tr_b16 v[228:229], v9 offset:45056
  v_mfma_f32_16x16x32_bf16 v[84:87], v[128:131], v[148:151], v[84:87]
  ds_read_b64_tr_b16 v[230:231], v9 offset:46080
  s_waitcnt lgkmcnt(15)
  v_mfma_f32_16x16x32_bf16 v[88:91], v[132:135], v[144:147], v[88:91]
  ds_read_b64_tr_b16 v[232:233], v10 offset:45056
  v_mfma_f32_16x16x32_bf16 v[92:95], v[132:135], v[148:151], v[92:95]
  ds_read_b64_tr_b16 v[234:235], v10 offset:46080
  s_waitcnt lgkmcnt(15)
  v_mfma_f32_16x16x32_bf16 v[96:99], v[136:139], v[144:147], v[96:99]
  ds_read_b64_tr_b16 v[236:237], v11 offset:45056
  v_mfma_f32_16x16x32_bf16 v[100:103], v[136:139], v[148:151], v[100:103]
  ds_read_b64_tr_b16 v[238:239], v11 offset:46080
  s_waitcnt lgkmcnt(15)
  v_mfma_f32_16x16x32_bf16 v[104:107], v[140:143], v[144:147], v[104:107]
  v_mfma_f32_16x16x32_bf16 v[108:111], v[140:143], v[148:151], v[108:111]
  v_xor_b32 v2, 0x10000, v2
  v_xor_b32 v3, 0x10000, v3
  v_xor_b32 v4, 0x10000, v4
  v_xor_b32 v5, 0x10000, v5
  v_xor_b32 v6, 0x10000, v6
  v_xor_b32 v7, 0x10000, v7
  v_xor_b32 v8, 0x10000, v8
  v_xor_b32 v9, 0x10000, v9
  v_xor_b32 v10, 0x10000, v10
  v_xor_b32 v11, 0x10000, v11
  s_waitcnt lgkmcnt(0)
  s_barrier
  v_mfma_f32_16x16x32_bf16 v[48:51], v[208:211], v[200:203], v[48:51]
  ds_read_b64_tr_b16 v[112:113], v4 offset:0
  ds_read_b64_tr_b16 v[114:115], v4 offset:1024
  v_mfma_f32_16x16x32_bf16 v[52:55], v[208:211], v[204:207], v[52:55]
  ds_read_b128 v[144:147], v2 offset:0
  ds_read_b128 v[148:151], v2 offset:2048
  v_mfma_f32_16x16x32_bf16 v[56:59], v[212:215], v[200:203], v[56:59]
  ds_read_b64_tr_b16 v[116:117], v5 offset:0
  ds_read_b64_tr_b16 v[118:119], v5 offset:1024
  v_mfma_f32_16x16x32_bf16 v[60:63], v[212:215], v[204:207], v[60:63]
  ds_read_b64_tr_b16 v[120:121], v6 offset:0
  ds_read_b64_tr_b16 v[122:123], v6 offset:1024
  v_mfma_f32_16x16x32_bf16 v[64:67], v[216:219], v[200:203], v[64:67]
  ds_read_b64_tr_b16 v[124:125], v7 offset:0
  v_mfma_f32_16x16x32_bf16 v[68:71], v[216:219], v[204:207], v[68:71]
  ds_read_b64_tr_b16 v[126:127], v7 offset:1024
  v_mfma_f32_16x16x32_bf16 v[72:75], v[220:223], v[200:203], v[72:75]
  ds_read_b64_tr_b16 v[128:129], v8 offset:0
  v_mfma_f32_16x16x32_bf16 v[76:79], v[220:223], v[204:207], v[76:79]
  ds_read_b64_tr_b16 v[130:131], v8 offset:1024
  v_mfma_f32_16x16x32_bf16 v[80:83], v[224:227], v[200:203], v[80:83]
  ds_read_b64_tr_b16 v[132:133], v9 offset:0
  v_mfma_f32_16x16x32_bf16 v[84:87], v[224:227], v[204:207], v[84:87]
  ds_read_b64_tr_b16 v[134:135], v9 offset:1024
  v_mfma_f32_16x16x32_bf16 v[88:91], v[228:231], v[200:203], v[88:91]
  ds_read_b64_tr_b16 v[136:137], v10 offset:0
  v_mfma_f32_16x16x32_bf16 v[92:95], v[228:231], v[204:207], v[92:95]
  ds_read_b64_tr_b16 v[138:139], v10 offset:1024
  v_mfma_f32_16x16x32_bf16 v[96:99], v[232:235], v[200:203], v[96:99]
  ds_read_b64_tr_b16 v[140:141], v11 offset:0
  v_mfma_f32_16x16x32_bf16 v[100:103], v[232:235], v[204:207], v[100:103]
  ds_read_b64_tr_b16 v[142:143], v11 offset:1024
  v_mfma_f32_16x16x32_bf16 v[104:107], v[236:239], v[200:203], v[104:107]
  v_mfma_f32_16x16x32_bf16 v[108:111], v[236:239], v[204:207], v[108:111]
  s_waitcnt lgkmcnt(15)
  v_mfma_f32_16x16x32_bf16 v[48:51], v[112:115], v[144:147], v[48:51]
  ds_read_b64_tr_b16 v[208:209], v4 offset:8192
  ds_read_b64_tr_b16 v[210:211], v4 offset:9216
  s_waitcnt lgkmcnt(15)
  v_mfma_f32_16x16x32_bf16 v[52:55], v[112:115], v[148:151], v[52:55]
  ds_read_b128 v[200:203], v3 offset:0
  ds_read_b128 v[204:207], v3 offset:2048
  s_waitcnt lgkmcnt(15)
  v_mfma_f32_16x16x32_bf16 v[56:59], v[116:119], v[144:147], v[56:59]
  ds_read_b64_tr_b16 v[212:213], v5 offset:8192
  ds_read_b64_tr_b16 v[214:215], v5 offset:9216
  v_mfma_f32_16x16x32_bf16 v[60:63], v[116:119], v[148:151], v[60:63]
  ds_read_b64_tr_b16 v[216:217], v6 offset:8192
  ds_read_b64_tr_b16 v[218:219], v6 offset:9216
  s_waitcnt lgkmcnt(15)
  v_mfma_f32_16x16x32_bf16 v[64:67], v[120:123], v[144:147], v[64:67]
  ds_read_b64_tr_b16 v[220:221], v7 offset:8192
  v_mfma_f32_16x16x32_bf16 v[68:71], v[120:123], v[148:151], v[68:71]
  ds_read_b64_tr_b16 v[222:223], v7 offset:9216
  s_waitcnt lgkmcnt(15)
  v_mfma_f32_16x16x32_bf16 v[72:75], v[124:127], v[144:147], v[72:75]
  ds_read_b64_tr_b16 v[224:225], v8 offset:8192
  v_mfma_f32_16x16x32_bf16 v[76:79], v[124:127], v[148:151], v[76:79]
  ds_read_b64_tr_b16 v[226:227], v8 offset:9216
  s_waitcnt lgkmcnt(15)
  v_mfma_f32_16x16x32_bf16 v[80:83], v[128:131], v[144:147], v[80:83]
  ds_read_b64_tr_b16 v[228:229], v9 offset:8192
  v_mfma_f32_16x16x32_bf16 v[84:87], v[128:131], v[148:151], v[84:87]
  ds_read_b64_tr_b16 v[230:231], v9 offset:9216
  s_waitcnt lgkmcnt(15)
  v_mfma_f32_16x16x32_bf16 v[88:91], v[132:135], v[144:147], v[88:91]
  ds_read_b64_tr_b16 v[232:233], v10 offset:8192
  v_mfma_f32_16x16x32_bf16 v[92:95], v[132:135], v[148:151], v[92:95]
  ds_read_b64_tr_b16 v[234:235], v10 offset:9216
  s_waitcnt lgkmcnt(15)
  v_mfma_f32_16x16x32_bf16 v[96:99], v[136:139], v[144:147], v[96:99]
  ds_read_b64_tr_b16 v[236:237], v11 offset:8192
  v_mfma_f32_16x16x32_bf16 v[100:103], v[136:139], v[148:151], v[100:103]
  ds_read_b64_tr_b16 v[238:239], v11 offset:9216
  s_waitcnt lgkmcnt(15)
  v_mfma_f32_16x16x32_bf16 v[104:107], v[140:143], v[144:147], v[104:107]
  v_mfma_f32_16x16x32_bf16 v[108:111], v[140:143], v[148:151], v[108:111]
  s_waitcnt lgkmcnt(0)
  s_barrier
  v_mfma_f32_16x16x32_bf16 v[48:51], v[208:211], v[200:203], v[48:51]
  ds_read_b64_tr_b16 v[112:113], v4 offset:32768
  ds_read_b64_tr_b16 v[114:115], v4 offset:33792
  v_mfma_f32_16x16x32_bf16 v[52:55], v[208:211], v[204:207], v[52:55]
  ds_read_b128 v[144:147], v2 offset:32768
  ds_read_b128 v[148:151], v2 offset:34816
  v_mfma_f32_16x16x32_bf16 v[56:59], v[212:215], v[200:203], v[56:59]
  ds_read_b64_tr_b16 v[116:117], v5 offset:32768
  ds_read_b64_tr_b16 v[118:119], v5 offset:33792
  v_mfma_f32_16x16x32_bf16 v[60:63], v[212:215], v[204:207], v[60:63]
  ds_read_b64_tr_b16 v[120:121], v6 offset:32768
  ds_read_b64_tr_b16 v[122:123], v6 offset:33792
  v_mfma_f32_16x16x32_bf16 v[64:67], v[216:219], v[200:203], v[64:67]
  ds_read_b64_tr_b16 v[124:125], v7 offset:32768
  v_mfma_f32_16x16x32_bf16 v[68:71], v[216:219], v[204:207], v[68:71]
  ds_read_b64_tr_b16 v[126:127], v7 offset:33792
  v_mfma_f32_16x16x32_bf16 v[72:75], v[220:223], v[200:203], v[72:75]
  ds_read_b64_tr_b16 v[128:129], v8 offset:32768
  v_mfma_f32_16x16x32_bf16 v[76:79], v[220:223], v[204:207], v[76:79]
  ds_read_b64_tr_b16 v[130:131], v8 offset:33792
  v_mfma_f32_16x16x32_bf16 v[80:83], v[224:227], v[200:203], v[80:83]
  ds_read_b64_tr_b16 v[132:133], v9 offset:32768
  v_mfma_f32_16x16x32_bf16 v[84:87], v[224:227], v[204:207], v[84:87]
  ds_read_b64_tr_b16 v[134:135], v9 offset:33792
  v_mfma_f32_16x16x32_bf16 v[88:91], v[228:231], v[200:203], v[88:91]
  ds_read_b64_tr_b16 v[136:137], v10 offset:32768
  v_mfma_f32_16x16x32_bf16 v[92:95], v[228:231], v[204:207], v[92:95]
  ds_read_b64_tr_b16 v[138:139], v10 offset:33792
  v_mfma_f32_16x16x32_bf16 v[96:99], v[232:235], v[200:203], v[96:99]
  ds_read_b64_tr_b16 v[140:141], v11 offset:32768
  v_mfma_f32_16x16x32_bf16 v[100:103], v[232:235], v[204:207], v[100:103]
  ds_read_b64_tr_b16 v[142:143], v11 offset:33792
  v_mfma_f32_16x16x32_bf16 v[104:107], v[236:239], v[200:203], v[104:107]
  v_mfma_f32_16x16x32_bf16 v[108:111], v[236:239], v[204:207], v[108:111]
  s_waitcnt lgkmcnt(15)
  v_mfma_f32_16x16x32_bf16 v[48:51], v[112:115], v[144:147], v[48:51]
  ds_read_b64_tr_b16 v[208:209], v4 offset:40960
  ds_read_b64_tr_b16 v[210:211], v4 offset:41984
  s_waitcnt lgkmcnt(15)
  v_mfma_f32_16x16x32_bf16 v[52:55], v[112:115], v[148:151], v[52:55]
  ds_read_b128 v[200:203], v3 offset:32768
  ds_read_b128 v[204:207], v3 offset:34816
  s_waitcnt lgkmcnt(15)
  v_mfma_f32_16x16x32_bf16 v[56:59], v[116:119], v[144:147], v[56:59]
  ds_read_b64_tr_b16 v[212:213], v5 offset:40960
  ds_read_b64_tr_b16 v[214:215], v5 offset:41984
  v_mfma_f32_16x16x32_bf16 v[60:63], v[116:119], v[148:151], v[60:63]
  ds_read_b64_tr_b16 v[216:217], v6 offset:40960
  ds_read_b64_tr_b16 v[218:219], v6 offset:41984
  s_waitcnt lgkmcnt(15)
  v_mfma_f32_16x16x32_bf16 v[64:67], v[120:123], v[144:147], v[64:67]
  ds_read_b64_tr_b16 v[220:221], v7 offset:40960
  v_mfma_f32_16x16x32_bf16 v[68:71], v[120:123], v[148:151], v[68:71]
  ds_read_b64_tr_b16 v[222:223], v7 offset:41984
  s_waitcnt lgkmcnt(15)
  v_mfma_f32_16x16x32_bf16 v[72:75], v[124:127], v[144:147], v[72:75]
  ds_read_b64_tr_b16 v[224:225], v8 offset:40960
  v_mfma_f32_16x16x32_bf16 v[76:79], v[124:127], v[148:151], v[76:79]
  ds_read_b64_tr_b16 v[226:227], v8 offset:41984
  s_waitcnt lgkmcnt(15)
  v_mfma_f32_16x16x32_bf16 v[80:83], v[128:131], v[144:147], v[80:83]
  ds_read_b64_tr_b16 v[228:229], v9 offset:40960
  v_mfma_f32_16x16x32_bf16 v[84:87], v[128:131], v[148:151], v[84:87]
  ds_read_b64_tr_b16 v[230:231], v9 offset:41984
  s_waitcnt lgkmcnt(15)
  v_mfma_f32_16x16x32_bf16 v[88:91], v[132:135], v[144:147], v[88:91]
  ds_read_b64_tr_b16 v[232:233], v10 offset:40960
  v_mfma_f32_16x16x32_bf16 v[92:95], v[132:135], v[148:151], v[92:95]
  ds_read_b64_tr_b16 v[234:235], v10 offset:41984
  s_waitcnt lgkmcnt(15)
  v_mfma_f32_16x16x32_bf16 v[96:99], v[136:139], v[144:147], v[96:99]
  ds_read_b64_tr_b16 v[236:237], v11 offset:40960
  v_mfma_f32_16x16x32_bf16 v[100:103], v[136:139], v[148:151], v[100:103]
  ds_read_b64_tr_b16 v[238:239], v11 offset:41984
  s_waitcnt lgkmcnt(15)
  v_mfma_f32_16x16x32_bf16 v[104:107], v[140:143], v[144:147], v[104:107]
  v_mfma_f32_16x16x32_bf16 v[108:111], v[140:143], v[148:151], v[108:111]
  v_xor_b32 v2, 0x10000, v2
  v_xor_b32 v3, 0x10000, v3
  v_xor_b32 v4, 0x10000, v4
  v_xor_b32 v5, 0x10000, v5
  v_xor_b32 v6, 0x10000, v6
  v_xor_b32 v7, 0x10000, v7
  v_xor_b32 v8, 0x10000, v8
  v_xor_b32 v9, 0x10000, v9
  v_xor_b32 v10, 0x10000, v10
  v_xor_b32 v11, 0x10000, v11
  s_waitcnt lgkmcnt(0)
  s_barrier
  v_mfma_f32_16x16x32_bf16 v[48:51], v[208:211], v[200:203], v[48:51]
  ds_read_b64_tr_b16 v[112:113], v4 offset:0
  ds_read_b64_tr_b16 v[114:115], v4 offset:1024
  v_mfma_f32_16x16x32_bf16 v[52:55], v[208:211], v[204:207], v[52:55]
  ds_read_b128 v[144:147], v2 offset:0
  ds_read_b128 v[148:151], v2 offset:2048
  v_mfma_f32_16x16x32_bf16 v[56:59], v[212:215], v[200:203], v[56:59]
  ds_read_b64_tr_b16 v[116:117], v5 offset:0
  ds_read_b64_tr_b16 v[118:119], v5 offset:1024
  v_mfma_f32_16x16x32_bf16 v[60:63], v[212:215], v[204:207], v[60:63]
  ds_read_b64_tr_b16 v[120:121], v6 offset:0
  ds_read_b64_tr_b16 v[122:123], v6 offset:1024
  v_mfma_f32_16x16x32_bf16 v[64:67], v[216:219], v[200:203], v[64:67]
  ds_read_b64_tr_b16 v[124:125], v7 offset:0
  v_mfma_f32_16x16x32_bf16 v[68:71], v[216:219], v[204:207], v[68:71]
  ds_read_b64_tr_b16 v[126:127], v7 offset:1024
  v_mfma_f32_16x16x32_bf16 v[72:75], v[220:223], v[200:203], v[72:75]
  ds_read_b64_tr_b16 v[128:129], v8 offset:0
  v_mfma_f32_16x16x32_bf16 v[76:79], v[220:223], v[204:207], v[76:79]
  ds_read_b64_tr_b16 v[130:131], v8 offset:1024
  v_mfma_f32_16x16x32_bf16 v[80:83], v[224:227], v[200:203], v[80:83]
  ds_read_b64_tr_b16 v[132:133], v9 offset:0
  v_mfma_f32_16x16x32_bf16 v[84:87], v[224:227], v[204:207], v[84:87]
  ds_read_b64_tr_b16 v[134:135], v9 offset:1024
  v_mfma_f32_16x16x32_bf16 v[88:91], v[228:231], v[200:203], v[88:91]
  ds_read_b64_tr_b16 v[136:137], v10 offset:0
  v_mfma_f32_16x16x32_bf16 v[92:95], v[228:231], v[204:207], v[92:95]
  ds_read_b64_tr_b16 v[138:139], v10 offset:1024
  v_mfma_f32_16x16x32_bf16 v[96:99], v[232:235], v[200:203], v[96:99]
  ds_read_b64_tr_b16 v[140:141], v11 offset:0
  v_mfma_f32_16x16x32_bf16 v[100:103], v[232:235], v[204:207], v[100:103]
  ds_read_b64_tr_b16 v[142:143], v11 offset:1024
  v_mfma_f32_16x16x32_bf16 v[104:107], v[236:239], v[200:203], v[104:107]
  v_mfma_f32_16x16x32_bf16 v[108:111], v[236:239], v[204:207], v[108:111]
  s_waitcnt lgkmcnt(15)
  v_mfma_f32_16x16x32_bf16 v[48:51], v[112:115], v[144:147], v[48:51]
  ds_read_b64_tr_b16 v[208:209], v4 offset:8192
  ds_read_b64_tr_b16 v[210:211], v4 offset:9216
  s_waitcnt lgkmcnt(15)
  v_mfma_f32_16x16x32_bf16 v[52:55], v[112:115], v[148:151], v[52:55]
  ds_read_b128 v[200:203], v3 offset:0
  ds_read_b128 v[204:207], v3 offset:2048
  s_waitcnt lgkmcnt(15)
  v_mfma_f32_16x16x32_bf16 v[56:59], v[116:119], v[144:147], v[56:59]
  ds_read_b64_tr_b16 v[212:213], v5 offset:8192
  ds_read_b64_tr_b16 v[214:215], v5 offset:9216
  v_mfma_f32_16x16x32_bf16 v[60:63], v[116:119], v[148:151], v[60:63]
  ds_read_b64_tr_b16 v[216:217], v6 offset:8192
  ds_read_b64_tr_b16 v[218:219], v6 offset:9216
  s_waitcnt lgkmcnt(15)
  v_mfma_f32_16x16x32_bf16 v[64:67], v[120:123], v[144:147], v[64:67]
  ds_read_b64_tr_b16 v[220:221], v7 offset:8192
  v_mfma_f32_16x16x32_bf16 v[68:71], v[120:123], v[148:151], v[68:71]
  ds_read_b64_tr_b16 v[222:223], v7 offset:9216
  s_waitcnt lgkmcnt(15)
  v_mfma_f32_16x16x32_bf16 v[72:75], v[124:127], v[144:147], v[72:75]
  ds_read_b64_tr_b16 v[224:225], v8 offset:8192
  v_mfma_f32_16x16x32_bf16 v[76:79], v[124:127], v[148:151], v[76:79]
  ds_read_b64_tr_b16 v[226:227], v8 offset:9216
  s_waitcnt lgkmcnt(15)
  v_mfma_f32_16x16x32_bf16 v[80:83], v[128:131], v[144:147], v[80:83]
  ds_read_b64_tr_b16 v[228:229], v9 offset:8192
  v_mfma_f32_16x16x32_bf16 v[84:87], v[128:131], v[148:151], v[84:87]
  ds_read_b64_tr_b16 v[230:231], v9 offset:9216
  s_waitcnt lgkmcnt(15)
  v_mfma_f32_16x16x32_bf16 v[88:91], v[132:135], v[144:147], v[88:91]
  ds_read_b64_tr_b16 v[232:233], v10 offset:8192
  v_mfma_f32_16x16x32_bf16 v[92:95], v[132:135], v[148:151], v[92:95]
  ds_read_b64_tr_b16 v[234:235], v10 offset:9216
  s_waitcnt lgkmcnt(15)
  v_mfma_f32_16x16x32_bf16 v[96:99], v[136:139], v[144:147], v[96:99]
  ds_read_b64_tr_b16 v[236:237], v11 offset:8192
  v_mfma_f32_16x16x32_bf16 v[100:103], v[136:139], v[148:151], v[100:103]
  ds_read_b64_tr_b16 v[238:239], v11 offset:9216
  s_waitcnt lgkmcnt(15)
  v_mfma_f32_16x16x32_bf16 v[104:107], v[140:143], v[144:147], v[104:107]
  v_mfma_f32_16x16x32_bf16 v[108:111], v[140:143], v[148:151], v[108:111]
  s_waitcnt lgkmcnt(0)
  s_barrier
  v_mfma_f32_16x16x32_bf16 v[48:51], v[208:211], v[200:203], v[48:51]
  ds_read_b64_tr_b16 v[112:113], v4 offset:36864
  ds_read_b64_tr_b16 v[114:115], v4 offset:37888
  v_mfma_f32_16x16x32_bf16 v[52:55], v[208:211], v[204:207], v[52:55]
  ds_read_b128 v[144:147], v2 offset:36864
  ds_read_b128 v[148:151], v2 offset:38912
  v_mfma_f32_16x16x32_bf16 v[56:59], v[212:215], v[200:203], v[56:59]
  ds_read_b64_tr_b16 v[116:117], v5 offset:36864
  ds_read_b64_tr_b16 v[118:119], v5 offset:37888
  v_mfma_f32_16x16x32_bf16 v[60:63], v[212:215], v[204:207], v[60:63]
  ds_read_b64_tr_b16 v[120:121], v6 offset:36864
  ds_read_b64_tr_b16 v[122:123], v6 offset:37888
  v_mfma_f32_16x16x32_bf16 v[64:67], v[216:219], v[200:203], v[64:67]
  ds_read_b64_tr_b16 v[124:125], v7 offset:36864
  v_mfma_f32_16x16x32_bf16 v[68:71], v[216:219], v[204:207], v[68:71]
  ds_read_b64_tr_b16 v[126:127], v7 offset:37888
  v_mfma_f32_16x16x32_bf16 v[72:75], v[220:223], v[200:203], v[72:75]
  ds_read_b64_tr_b16 v[128:129], v8 offset:36864
  v_mfma_f32_16x16x32_bf16 v[76:79], v[220:223], v[204:207], v[76:79]
  ds_read_b64_tr_b16 v[130:131], v8 offset:37888
  v_mfma_f32_16x16x32_bf16 v[80:83], v[224:227], v[200:203], v[80:83]
  ds_read_b64_tr_b16 v[132:133], v9 offset:36864
  v_mfma_f32_16x16x32_bf16 v[84:87], v[224:227], v[204:207], v[84:87]
  ds_read_b64_tr_b16 v[134:135], v9 offset:37888
  v_mfma_f32_16x16x32_bf16 v[88:91], v[228:231], v[200:203], v[88:91]
  ds_read_b64_tr_b16 v[136:137], v10 offset:36864
  v_mfma_f32_16x16x32_bf16 v[92:95], v[228:231], v[204:207], v[92:95]
  ds_read_b64_tr_b16 v[138:139], v10 offset:37888
  v_mfma_f32_16x16x32_bf16 v[96:99], v[232:235], v[200:203], v[96:99]
  ds_read_b64_tr_b16 v[140:141], v11 offset:36864
  v_mfma_f32_16x16x32_bf16 v[100:103], v[232:235], v[204:207], v[100:103]
  ds_read_b64_tr_b16 v[142:143], v11 offset:37888
  v_mfma_f32_16x16x32_bf16 v[104:107], v[236:239], v[200:203], v[104:107]
  v_mfma_f32_16x16x32_bf16 v[108:111], v[236:239], v[204:207], v[108:111]
  s_waitcnt lgkmcnt(15)
  v_mfma_f32_16x16x32_bf16 v[48:51], v[112:115], v[144:147], v[48:51]
  ds_read_b64_tr_b16 v[208:209], v4 offset:45056
  ds_read_b64_tr_b16 v[210:211], v4 offset:46080
  s_waitcnt lgkmcnt(15)
  v_mfma_f32_16x16x32_bf16 v[52:55], v[112:115], v[148:151], v[52:55]
  ds_read_b128 v[200:203], v3 offset:36864
  ds_read_b128 v[204:207], v3 offset:38912
  s_waitcnt lgkmcnt(15)
  v_mfma_f32_16x16x32_bf16 v[56:59], v[116:119], v[144:147], v[56:59]
  ds_read_b64_tr_b16 v[212:213], v5 offset:45056
  ds_read_b64_tr_b16 v[214:215], v5 offset:46080
  v_mfma_f32_16x16x32_bf16 v[60:63], v[116:119], v[148:151], v[60:63]
  ds_read_b64_tr_b16 v[216:217], v6 offset:45056
  ds_read_b64_tr_b16 v[218:219], v6 offset:46080
  s_waitcnt lgkmcnt(15)
  v_mfma_f32_16x16x32_bf16 v[64:67], v[120:123], v[144:147], v[64:67]
  ds_read_b64_tr_b16 v[220:221], v7 offset:45056
  v_mfma_f32_16x16x32_bf16 v[68:71], v[120:123], v[148:151], v[68:71]
  ds_read_b64_tr_b16 v[222:223], v7 offset:46080
  s_waitcnt lgkmcnt(15)
  v_mfma_f32_16x16x32_bf16 v[72:75], v[124:127], v[144:147], v[72:75]
  ds_read_b64_tr_b16 v[224:225], v8 offset:45056
  v_mfma_f32_16x16x32_bf16 v[76:79], v[124:127], v[148:151], v[76:79]
  ds_read_b64_tr_b16 v[226:227], v8 offset:46080
  s_waitcnt lgkmcnt(15)
  v_mfma_f32_16x16x32_bf16 v[80:83], v[128:131], v[144:147], v[80:83]
  ds_read_b64_tr_b16 v[228:229], v9 offset:45056
  v_mfma_f32_16x16x32_bf16 v[84:87], v[128:131], v[148:151], v[84:87]
  ds_read_b64_tr_b16 v[230:231], v9 offset:46080
  s_waitcnt lgkmcnt(15)
  v_mfma_f32_16x16x32_bf16 v[88:91], v[132:135], v[144:147], v[88:91]
  ds_read_b64_tr_b16 v[232:233], v10 offset:45056
  v_mfma_f32_16x16x32_bf16 v[92:95], v[132:135], v[148:151], v[92:95]
  ds_read_b64_tr_b16 v[234:235], v10 offset:46080
  s_waitcnt lgkmcnt(15)
  v_mfma_f32_16x16x32_bf16 v[96:99], v[136:139], v[144:147], v[96:99]
  ds_read_b64_tr_b16 v[236:237], v11 offset:45056
  v_mfma_f32_16x16x32_bf16 v[100:103], v[136:139], v[148:151], v[100:103]
  ds_read_b64_tr_b16 v[238:239], v11 offset:46080
  s_waitcnt lgkmcnt(15)
  v_mfma_f32_16x16x32_bf16 v[104:107], v[140:143], v[144:147], v[104:107]
  v_mfma_f32_16x16x32_bf16 v[108:111], v[140:143], v[148:151], v[108:111]
  v_xor_b32 v2, 0x10000, v2
  v_xor_b32 v3, 0x10000, v3
  v_xor_b32 v4, 0x10000, v4
  v_xor_b32 v5, 0x10000, v5
  v_xor_b32 v6, 0x10000, v6
  v_xor_b32 v7, 0x10000, v7
  v_xor_b32 v8, 0x10000, v8
  v_xor_b32 v9, 0x10000, v9
  v_xor_b32 v10, 0x10000, v10
  v_xor_b32 v11, 0x10000, v11
  s_waitcnt lgkmcnt(0)
  s_barrier
  v_mfma_f32_16x16x32_bf16 v[48:51], v[208:211], v[200:203], v[48:51]
  ds_read_b64_tr_b16 v[112:113], v4 offset:0
  ds_read_b64_tr_b16 v[114:115], v4 offset:1024
  v_mfma_f32_16x16x32_bf16 v[52:55], v[208:211], v[204:207], v[52:55]
  ds_read_b128 v[144:147], v2 offset:0
  ds_read_b128 v[148:151], v2 offset:2048
  v_mfma_f32_16x16x32_bf16 v[56:59], v[212:215], v[200:203], v[56:59]
  ds_read_b64_tr_b16 v[116:117], v5 offset:0
  ds_read_b64_tr_b16 v[118:119], v5 offset:1024
  v_mfma_f32_16x16x32_bf16 v[60:63], v[212:215], v[204:207], v[60:63]
  ds_read_b64_tr_b16 v[120:121], v6 offset:0
  ds_read_b64_tr_b16 v[122:123], v6 offset:1024
  v_mfma_f32_16x16x32_bf16 v[64:67], v[216:219], v[200:203], v[64:67]
  ds_read_b64_tr_b16 v[124:125], v7 offset:0
  v_mfma_f32_16x16x32_bf16 v[68:71], v[216:219], v[204:207], v[68:71]
  ds_read_b64_tr_b16 v[126:127], v7 offset:1024
  v_mfma_f32_16x16x32_bf16 v[72:75], v[220:223], v[200:203], v[72:75]
  ds_read_b64_tr_b16 v[128:129], v8 offset:0
  v_mfma_f32_16x16x32_bf16 v[76:79], v[220:223], v[204:207], v[76:79]
  ds_read_b64_tr_b16 v[130:131], v8 offset:1024
  v_mfma_f32_16x16x32_bf16 v[80:83], v[224:227], v[200:203], v[80:83]
  ds_read_b64_tr_b16 v[132:133], v9 offset:0
  v_mfma_f32_16x16x32_bf16 v[84:87], v[224:227], v[204:207], v[84:87]
  ds_read_b64_tr_b16 v[134:135], v9 offset:1024
  v_mfma_f32_16x16x32_bf16 v[88:91], v[228:231], v[200:203], v[88:91]
  ds_read_b64_tr_b16 v[136:137], v10 offset:0
  v_mfma_f32_16x16x32_bf16 v[92:95], v[228:231], v[204:207], v[92:95]
  ds_read_b64_tr_b16 v[138:139], v10 offset:1024
  v_mfma_f32_16x16x32_bf16 v[96:99], v[232:235], v[200:203], v[96:99]
  ds_read_b64_tr_b16 v[140:141], v11 offset:0
  v_mfma_f32_16x16x32_bf16 v[100:103], v[232:235], v[204:207], v[100:103]
  ds_read_b64_tr_b16 v[142:143], v11 offset:1024
  v_mfma_f32_16x16x32_bf16 v[104:107], v[236:239], v[200:203], v[104:107]
  v_mfma_f32_16x16x32_bf16 v[108:111], v[236:239], v[204:207], v[108:111]
  s_waitcnt lgkmcnt(15)
  v_mfma_f32_16x16x32_bf16 v[48:51], v[112:115], v[144:147], v[48:51]
  ds_read_b64_tr_b16 v[208:209], v4 offset:8192
  ds_read_b64_tr_b16 v[210:211], v4 offset:9216
  s_waitcnt lgkmcnt(15)
  v_mfma_f32_16x16x32_bf16 v[52:55], v[112:115], v[148:151], v[52:55]
  ds_read_b128 v[200:203], v3 offset:0
  ds_read_b128 v[204:207], v3 offset:2048
  s_waitcnt lgkmcnt(15)
  v_mfma_f32_16x16x32_bf16 v[56:59], v[116:119], v[144:147], v[56:59]
  ds_read_b64_tr_b16 v[212:213], v5 offset:8192
  ds_read_b64_tr_b16 v[214:215], v5 offset:9216
  v_mfma_f32_16x16x32_bf16 v[60:63], v[116:119], v[148:151], v[60:63]
  ds_read_b64_tr_b16 v[216:217], v6 offset:8192
  ds_read_b64_tr_b16 v[218:219], v6 offset:9216
  s_waitcnt lgkmcnt(15)
  v_mfma_f32_16x16x32_bf16 v[64:67], v[120:123], v[144:147], v[64:67]
  ds_read_b64_tr_b16 v[220:221], v7 offset:8192
  v_mfma_f32_16x16x32_bf16 v[68:71], v[120:123], v[148:151], v[68:71]
  ds_read_b64_tr_b16 v[222:223], v7 offset:9216
  s_waitcnt lgkmcnt(15)
  v_mfma_f32_16x16x32_bf16 v[72:75], v[124:127], v[144:147], v[72:75]
  ds_read_b64_tr_b16 v[224:225], v8 offset:8192
  v_mfma_f32_16x16x32_bf16 v[76:79], v[124:127], v[148:151], v[76:79]
  ds_read_b64_tr_b16 v[226:227], v8 offset:9216
  s_waitcnt lgkmcnt(15)
  v_mfma_f32_16x16x32_bf16 v[80:83], v[128:131], v[144:147], v[80:83]
  ds_read_b64_tr_b16 v[228:229], v9 offset:8192
  v_mfma_f32_16x16x32_bf16 v[84:87], v[128:131], v[148:151], v[84:87]
  ds_read_b64_tr_b16 v[230:231], v9 offset:9216
  s_waitcnt lgkmcnt(15)
  v_mfma_f32_16x16x32_bf16 v[88:91], v[132:135], v[144:147], v[88:91]
  ds_read_b64_tr_b16 v[232:233], v10 offset:8192
  v_mfma_f32_16x16x32_bf16 v[92:95], v[132:135], v[148:151], v[92:95]
  ds_read_b64_tr_b16 v[234:235], v10 offset:9216
  s_waitcnt lgkmcnt(15)
  v_mfma_f32_16x16x32_bf16 v[96:99], v[136:139], v[144:147], v[96:99]
  ds_read_b64_tr_b16 v[236:237], v11 offset:8192
  v_mfma_f32_16x16x32_bf16 v[100:103], v[136:139], v[148:151], v[100:103]
  ds_read_b64_tr_b16 v[238:239], v11 offset:9216
  s_waitcnt lgkmcnt(15)
  v_mfma_f32_16x16x32_bf16 v[104:107], v[140:143], v[144:147], v[104:107]
  v_mfma_f32_16x16x32_bf16 v[108:111], v[140:143], v[148:151], v[108:111]
  s_waitcnt lgkmcnt(0)
  s_barrier
  v_mfma_f32_16x16x32_bf16 v[48:51], v[208:211], v[200:203], v[48:51]
  ds_read_b64_tr_b16 v[112:113], v4 offset:32768
  ds_read_b64_tr_b16 v[114:115], v4 offset:33792
  v_mfma_f32_16x16x32_bf16 v[52:55], v[208:211], v[204:207], v[52:55]
  ds_read_b128 v[144:147], v2 offset:32768
  ds_read_b128 v[148:151], v2 offset:34816
  v_mfma_f32_16x16x32_bf16 v[56:59], v[212:215], v[200:203], v[56:59]
  ds_read_b64_tr_b16 v[116:117], v5 offset:32768
  ds_read_b64_tr_b16 v[118:119], v5 offset:33792
  v_mfma_f32_16x16x32_bf16 v[60:63], v[212:215], v[204:207], v[60:63]
  ds_read_b64_tr_b16 v[120:121], v6 offset:32768
  ds_read_b64_tr_b16 v[122:123], v6 offset:33792
  v_mfma_f32_16x16x32_bf16 v[64:67], v[216:219], v[200:203], v[64:67]
  ds_read_b64_tr_b16 v[124:125], v7 offset:32768
  v_mfma_f32_16x16x32_bf16 v[68:71], v[216:219], v[204:207], v[68:71]
  ds_read_b64_tr_b16 v[126:127], v7 offset:33792
  v_mfma_f32_16x16x32_bf16 v[72:75], v[220:223], v[200:203], v[72:75]
  ds_read_b64_tr_b16 v[128:129], v8 offset:32768
  v_mfma_f32_16x16x32_bf16 v[76:79], v[220:223], v[204:207], v[76:79]
  ds_read_b64_tr_b16 v[130:131], v8 offset:33792
  v_mfma_f32_16x16x32_bf16 v[80:83], v[224:227], v[200:203], v[80:83]
  ds_read_b64_tr_b16 v[132:133], v9 offset:32768
  v_mfma_f32_16x16x32_bf16 v[84:87], v[224:227], v[204:207], v[84:87]
  ds_read_b64_tr_b16 v[134:135], v9 offset:33792
  v_mfma_f32_16x16x32_bf16 v[88:91], v[228:231], v[200:203], v[88:91]
  ds_read_b64_tr_b16 v[136:137], v10 offset:32768
  v_mfma_f32_16x16x32_bf16 v[92:95], v[228:231], v[204:207], v[92:95]
  ds_read_b64_tr_b16 v[138:139], v10 offset:33792
  v_mfma_f32_16x16x32_bf16 v[96:99], v[232:235], v[200:203], v[96:99]
  ds_read_b64_tr_b16 v[140:141], v11 offset:32768
  v_mfma_f32_16x16x32_bf16 v[100:103], v[232:235], v[204:207], v[100:103]
  ds_read_b64_tr_b16 v[142:143], v11 offset:33792
  v_mfma_f32_16x16x32_bf16 v[104:107], v[236:239], v[200:203], v[104:107]
  v_mfma_f32_16x16x32_bf16 v[108:111], v[236:239], v[204:207], v[108:111]
  s_waitcnt lgkmcnt(15)
  v_mfma_f32_16x16x32_bf16 v[48:51], v[112:115], v[144:147], v[48:51]
  ds_read_b64_tr_b16 v[208:209], v4 offset:40960
  ds_read_b64_tr_b16 v[210:211], v4 offset:41984
  s_waitcnt lgkmcnt(15)
  v_mfma_f32_16x16x32_bf16 v[52:55], v[112:115], v[148:151], v[52:55]
  ds_read_b128 v[200:203], v3 offset:32768
  ds_read_b128 v[204:207], v3 offset:34816
  s_waitcnt lgkmcnt(15)
  v_mfma_f32_16x16x32_bf16 v[56:59], v[116:119], v[144:147], v[56:59]
  ds_read_b64_tr_b16 v[212:213], v5 offset:40960
  ds_read_b64_tr_b16 v[214:215], v5 offset:41984
  v_mfma_f32_16x16x32_bf16 v[60:63], v[116:119], v[148:151], v[60:63]
  ds_read_b64_tr_b16 v[216:217], v6 offset:40960
  ds_read_b64_tr_b16 v[218:219], v6 offset:41984
  s_waitcnt lgkmcnt(15)
  v_mfma_f32_16x16x32_bf16 v[64:67], v[120:123], v[144:147], v[64:67]
  ds_read_b64_tr_b16 v[220:221], v7 offset:40960
  v_mfma_f32_16x16x32_bf16 v[68:71], v[120:123], v[148:151], v[68:71]
  ds_read_b64_tr_b16 v[222:223], v7 offset:41984
  s_waitcnt lgkmcnt(15)
  v_mfma_f32_16x16x32_bf16 v[72:75], v[124:127], v[144:147], v[72:75]
  ds_read_b64_tr_b16 v[224:225], v8 offset:40960
  v_mfma_f32_16x16x32_bf16 v[76:79], v[124:127], v[148:151], v[76:79]
  ds_read_b64_tr_b16 v[226:227], v8 offset:41984
  s_waitcnt lgkmcnt(15)
  v_mfma_f32_16x16x32_bf16 v[80:83], v[128:131], v[144:147], v[80:83]
  ds_read_b64_tr_b16 v[228:229], v9 offset:40960
  v_mfma_f32_16x16x32_bf16 v[84:87], v[128:131], v[148:151], v[84:87]
  ds_read_b64_tr_b16 v[230:231], v9 offset:41984
  s_waitcnt lgkmcnt(15)
  v_mfma_f32_16x16x32_bf16 v[88:91], v[132:135], v[144:147], v[88:91]
  ds_read_b64_tr_b16 v[232:233], v10 offset:40960
  v_mfma_f32_16x16x32_bf16 v[92:95], v[132:135], v[148:151], v[92:95]
  ds_read_b64_tr_b16 v[234:235], v10 offset:41984
  s_waitcnt lgkmcnt(15)
  v_mfma_f32_16x16x32_bf16 v[96:99], v[136:139], v[144:147], v[96:99]
  ds_read_b64_tr_b16 v[236:237], v11 offset:40960
  v_mfma_f32_16x16x32_bf16 v[100:103], v[136:139], v[148:151], v[100:103]
  ds_read_b64_tr_b16 v[238:239], v11 offset:41984
  s_waitcnt lgkmcnt(15)
  v_mfma_f32_16x16x32_bf16 v[104:107], v[140:143], v[144:147], v[104:107]
  v_mfma_f32_16x16x32_bf16 v[108:111], v[140:143], v[148:151], v[108:111]
  v_xor_b32 v2, 0x10000, v2
  v_xor_b32 v3, 0x10000, v3
  v_xor_b32 v4, 0x10000, v4
  v_xor_b32 v5, 0x10000, v5
  v_xor_b32 v6, 0x10000, v6
  v_xor_b32 v7, 0x10000, v7
  v_xor_b32 v8, 0x10000, v8
  v_xor_b32 v9, 0x10000, v9
  v_xor_b32 v10, 0x10000, v10
  v_xor_b32 v11, 0x10000, v11
  s_waitcnt lgkmcnt(0)
  s_barrier
  v_mfma_f32_16x16x32_bf16 v[48:51], v[208:211], v[200:203], v[48:51]
  ds_read_b64_tr_b16 v[112:113], v4 offset:0
  ds_read_b64_tr_b16 v[114:115], v4 offset:1024
  v_mfma_f32_16x16x32_bf16 v[52:55], v[208:211], v[204:207], v[52:55]
  ds_read_b128 v[144:147], v2 offset:0
  ds_read_b128 v[148:151], v2 offset:2048
  v_mfma_f32_16x16x32_bf16 v[56:59], v[212:215], v[200:203], v[56:59]
  ds_read_b64_tr_b16 v[116:117], v5 offset:0
  ds_read_b64_tr_b16 v[118:119], v5 offset:1024
  v_mfma_f32_16x16x32_bf16 v[60:63], v[212:215], v[204:207], v[60:63]
  ds_read_b64_tr_b16 v[120:121], v6 offset:0
  ds_read_b64_tr_b16 v[122:123], v6 offset:1024
  v_mfma_f32_16x16x32_bf16 v[64:67], v[216:219], v[200:203], v[64:67]
  ds_read_b64_tr_b16 v[124:125], v7 offset:0
  v_mfma_f32_16x16x32_bf16 v[68:71], v[216:219], v[204:207], v[68:71]
  ds_read_b64_tr_b16 v[126:127], v7 offset:1024
  v_mfma_f32_16x16x32_bf16 v[72:75], v[220:223], v[200:203], v[72:75]
  ds_read_b64_tr_b16 v[128:129], v8 offset:0
  v_mfma_f32_16x16x32_bf16 v[76:79], v[220:223], v[204:207], v[76:79]
  ds_read_b64_tr_b16 v[130:131], v8 offset:1024
  v_mfma_f32_16x16x32_bf16 v[80:83], v[224:227], v[200:203], v[80:83]
  ds_read_b64_tr_b16 v[132:133], v9 offset:0
  v_mfma_f32_16x16x32_bf16 v[84:87], v[224:227], v[204:207], v[84:87]
  ds_read_b64_tr_b16 v[134:135], v9 offset:1024
  v_mfma_f32_16x16x32_bf16 v[88:91], v[228:231], v[200:203], v[88:91]
  ds_read_b64_tr_b16 v[136:137], v10 offset:0
  v_mfma_f32_16x16x32_bf16 v[92:95], v[228:231], v[204:207], v[92:95]
  ds_read_b64_tr_b16 v[138:139], v10 offset:1024
  v_mfma_f32_16x16x32_bf16 v[96:99], v[232:235], v[200:203], v[96:99]
  ds_read_b64_tr_b16 v[140:141], v11 offset:0
  v_mfma_f32_16x16x32_bf16 v[100:103], v[232:235], v[204:207], v[100:103]
  ds_read_b64_tr_b16 v[142:143], v11 offset:1024
  v_mfma_f32_16x16x32_bf16 v[104:107], v[236:239], v[200:203], v[104:107]
  v_mfma_f32_16x16x32_bf16 v[108:111], v[236:239], v[204:207], v[108:111]
  s_waitcnt lgkmcnt(15)
  v_mfma_f32_16x16x32_bf16 v[48:51], v[112:115], v[144:147], v[48:51]
  ds_read_b64_tr_b16 v[208:209], v4 offset:8192
  ds_read_b64_tr_b16 v[210:211], v4 offset:9216
  s_waitcnt lgkmcnt(15)
  v_mfma_f32_16x16x32_bf16 v[52:55], v[112:115], v[148:151], v[52:55]
  ds_read_b128 v[200:203], v3 offset:0
  ds_read_b128 v[204:207], v3 offset:2048
  s_waitcnt lgkmcnt(15)
  v_mfma_f32_16x16x32_bf16 v[56:59], v[116:119], v[144:147], v[56:59]
  ds_read_b64_tr_b16 v[212:213], v5 offset:8192
  ds_read_b64_tr_b16 v[214:215], v5 offset:9216
  v_mfma_f32_16x16x32_bf16 v[60:63], v[116:119], v[148:151], v[60:63]
  ds_read_b64_tr_b16 v[216:217], v6 offset:8192
  ds_read_b64_tr_b16 v[218:219], v6 offset:9216
  s_waitcnt lgkmcnt(15)
  v_mfma_f32_16x16x32_bf16 v[64:67], v[120:123], v[144:147], v[64:67]
  ds_read_b64_tr_b16 v[220:221], v7 offset:8192
  v_mfma_f32_16x16x32_bf16 v[68:71], v[120:123], v[148:151], v[68:71]
  ds_read_b64_tr_b16 v[222:223], v7 offset:9216
  s_waitcnt lgkmcnt(15)
  v_mfma_f32_16x16x32_bf16 v[72:75], v[124:127], v[144:147], v[72:75]
  ds_read_b64_tr_b16 v[224:225], v8 offset:8192
  v_mfma_f32_16x16x32_bf16 v[76:79], v[124:127], v[148:151], v[76:79]
  ds_read_b64_tr_b16 v[226:227], v8 offset:9216
  s_waitcnt lgkmcnt(15)
  v_mfma_f32_16x16x32_bf16 v[80:83], v[128:131], v[144:147], v[80:83]
  ds_read_b64_tr_b16 v[228:229], v9 offset:8192
  v_mfma_f32_16x16x32_bf16 v[84:87], v[128:131], v[148:151], v[84:87]
  ds_read_b64_tr_b16 v[230:231], v9 offset:9216
  s_waitcnt lgkmcnt(15)
  v_mfma_f32_16x16x32_bf16 v[88:91], v[132:135], v[144:147], v[88:91]
  ds_read_b64_tr_b16 v[232:233], v10 offset:8192
  v_mfma_f32_16x16x32_bf16 v[92:95], v[132:135], v[148:151], v[92:95]
  ds_read_b64_tr_b16 v[234:235], v10 offset:9216
  s_waitcnt lgkmcnt(15)
  v_mfma_f32_16x16x32_bf16 v[96:99], v[136:139], v[144:147], v[96:99]
  ds_read_b64_tr_b16 v[236:237], v11 offset:8192
  v_mfma_f32_16x16x32_bf16 v[100:103], v[136:139], v[148:151], v[100:103]
  ds_read_b64_tr_b16 v[238:239], v11 offset:9216
  s_waitcnt lgkmcnt(15)
  v_mfma_f32_16x16x32_bf16 v[104:107], v[140:143], v[144:147], v[104:107]
  v_mfma_f32_16x16x32_bf16 v[108:111], v[140:143], v[148:151], v[108:111]
  s_waitcnt lgkmcnt(0)
  s_barrier
  v_mfma_f32_16x16x32_bf16 v[48:51], v[208:211], v[200:203], v[48:51]
  ds_read_b64_tr_b16 v[112:113], v4 offset:36864
  ds_read_b64_tr_b16 v[114:115], v4 offset:37888
  v_mfma_f32_16x16x32_bf16 v[52:55], v[208:211], v[204:207], v[52:55]
  ds_read_b128 v[144:147], v2 offset:36864
  ds_read_b128 v[148:151], v2 offset:38912
  v_mfma_f32_16x16x32_bf16 v[56:59], v[212:215], v[200:203], v[56:59]
  ds_read_b64_tr_b16 v[116:117], v5 offset:36864
  ds_read_b64_tr_b16 v[118:119], v5 offset:37888
  v_mfma_f32_16x16x32_bf16 v[60:63], v[212:215], v[204:207], v[60:63]
  ds_read_b64_tr_b16 v[120:121], v6 offset:36864
  ds_read_b64_tr_b16 v[122:123], v6 offset:37888
  v_mfma_f32_16x16x32_bf16 v[64:67], v[216:219], v[200:203], v[64:67]
  ds_read_b64_tr_b16 v[124:125], v7 offset:36864
  v_mfma_f32_16x16x32_bf16 v[68:71], v[216:219], v[204:207], v[68:71]
  ds_read_b64_tr_b16 v[126:127], v7 offset:37888
  v_mfma_f32_16x16x32_bf16 v[72:75], v[220:223], v[200:203], v[72:75]
  ds_read_b64_tr_b16 v[128:129], v8 offset:36864
  v_mfma_f32_16x16x32_bf16 v[76:79], v[220:223], v[204:207], v[76:79]
  ds_read_b64_tr_b16 v[130:131], v8 offset:37888
  v_mfma_f32_16x16x32_bf16 v[80:83], v[224:227], v[200:203], v[80:83]
  ds_read_b64_tr_b16 v[132:133], v9 offset:36864
  v_mfma_f32_16x16x32_bf16 v[84:87], v[224:227], v[204:207], v[84:87]
  ds_read_b64_tr_b16 v[134:135], v9 offset:37888
  v_mfma_f32_16x16x32_bf16 v[88:91], v[228:231], v[200:203], v[88:91]
  ds_read_b64_tr_b16 v[136:137], v10 offset:36864
  v_mfma_f32_16x16x32_bf16 v[92:95], v[228:231], v[204:207], v[92:95]
  ds_read_b64_tr_b16 v[138:139], v10 offset:37888
  v_mfma_f32_16x16x32_bf16 v[96:99], v[232:235], v[200:203], v[96:99]
  ds_read_b64_tr_b16 v[140:141], v11 offset:36864
  v_mfma_f32_16x16x32_bf16 v[100:103], v[232:235], v[204:207], v[100:103]
  ds_read_b64_tr_b16 v[142:143], v11 offset:37888
  v_mfma_f32_16x16x32_bf16 v[104:107], v[236:239], v[200:203], v[104:107]
  v_mfma_f32_16x16x32_bf16 v[108:111], v[236:239], v[204:207], v[108:111]
  s_waitcnt lgkmcnt(15)
  v_mfma_f32_16x16x32_bf16 v[48:51], v[112:115], v[144:147], v[48:51]
  ds_read_b64_tr_b16 v[208:209], v4 offset:45056
  ds_read_b64_tr_b16 v[210:211], v4 offset:46080
  s_waitcnt lgkmcnt(15)
  v_mfma_f32_16x16x32_bf16 v[52:55], v[112:115], v[148:151], v[52:55]
  ds_read_b128 v[200:203], v3 offset:36864
  ds_read_b128 v[204:207], v3 offset:38912
  s_waitcnt lgkmcnt(15)
  v_mfma_f32_16x16x32_bf16 v[56:59], v[116:119], v[144:147], v[56:59]
  ds_read_b64_tr_b16 v[212:213], v5 offset:45056
  ds_read_b64_tr_b16 v[214:215], v5 offset:46080
  v_mfma_f32_16x16x32_bf16 v[60:63], v[116:119], v[148:151], v[60:63]
  ds_read_b64_tr_b16 v[216:217], v6 offset:45056
  ds_read_b64_tr_b16 v[218:219], v6 offset:46080
  s_waitcnt lgkmcnt(15)
  v_mfma_f32_16x16x32_bf16 v[64:67], v[120:123], v[144:147], v[64:67]
  ds_read_b64_tr_b16 v[220:221], v7 offset:45056
  v_mfma_f32_16x16x32_bf16 v[68:71], v[120:123], v[148:151], v[68:71]
  ds_read_b64_tr_b16 v[222:223], v7 offset:46080
  s_waitcnt lgkmcnt(15)
  v_mfma_f32_16x16x32_bf16 v[72:75], v[124:127], v[144:147], v[72:75]
  ds_read_b64_tr_b16 v[224:225], v8 offset:45056
  v_mfma_f32_16x16x32_bf16 v[76:79], v[124:127], v[148:151], v[76:79]
  ds_read_b64_tr_b16 v[226:227], v8 offset:46080
  s_waitcnt lgkmcnt(15)
  v_mfma_f32_16x16x32_bf16 v[80:83], v[128:131], v[144:147], v[80:83]
  ds_read_b64_tr_b16 v[228:229], v9 offset:45056
  v_mfma_f32_16x16x32_bf16 v[84:87], v[128:131], v[148:151], v[84:87]
  ds_read_b64_tr_b16 v[230:231], v9 offset:46080
  s_waitcnt lgkmcnt(15)
  v_mfma_f32_16x16x32_bf16 v[88:91], v[132:135], v[144:147], v[88:91]
  ds_read_b64_tr_b16 v[232:233], v10 offset:45056
  v_mfma_f32_16x16x32_bf16 v[92:95], v[132:135], v[148:151], v[92:95]
  ds_read_b64_tr_b16 v[234:235], v10 offset:46080
  s_waitcnt lgkmcnt(15)
  v_mfma_f32_16x16x32_bf16 v[96:99], v[136:139], v[144:147], v[96:99]
  ds_read_b64_tr_b16 v[236:237], v11 offset:45056
  v_mfma_f32_16x16x32_bf16 v[100:103], v[136:139], v[148:151], v[100:103]
  ds_read_b64_tr_b16 v[238:239], v11 offset:46080
  s_waitcnt lgkmcnt(15)
  v_mfma_f32_16x16x32_bf16 v[104:107], v[140:143], v[144:147], v[104:107]
  v_mfma_f32_16x16x32_bf16 v[108:111], v[140:143], v[148:151], v[108:111]
  s_waitcnt lgkmcnt(0)
  s_barrier
  v_mfma_f32_16x16x32_bf16 v[48:51], v[208:211], v[200:203], v[48:51]
  ds_read_b64_tr_b16 v[152:153], v30 offset:0
  ds_read_b64_tr_b16 v[154:155], v30 offset:160
  v_mfma_f32_16x16x32_bf16 v[52:55], v[208:211], v[204:207], v[52:55]
  ds_read_b64_tr_b16 v[156:157], v30 offset:32
  ds_read_b64_tr_b16 v[158:159], v30 offset:192
  v_mfma_f32_16x16x32_bf16 v[56:59], v[212:215], v[200:203], v[56:59]
  ds_read_b64_tr_b16 v[160:161], v30 offset:320
  ds_read_b64_tr_b16 v[162:163], v30 offset:480
  v_mfma_f32_16x16x32_bf16 v[60:63], v[212:215], v[204:207], v[60:63]
  ds_read_b64_tr_b16 v[164:165], v30 offset:352
  ds_read_b64_tr_b16 v[166:167], v30 offset:512
  v_mfma_f32_16x16x32_bf16 v[64:67], v[216:219], v[200:203], v[64:67]
  ds_read_b64_tr_b16 v[168:169], v30 offset:640
  v_mfma_f32_16x16x32_bf16 v[68:71], v[216:219], v[204:207], v[68:71]
  ds_read_b64_tr_b16 v[172:173], v30 offset:672
  v_mfma_f32_16x16x32_bf16 v[72:75], v[220:223], v[200:203], v[72:75]
  v_cvt_pk_bf16_f32 v116, v48, v49
  v_cvt_pk_bf16_f32 v117, v50, v51
  v_mfma_f32_16x16x32_bf16 v[76:79], v[220:223], v[204:207], v[76:79]
  v_cvt_pk_bf16_f32 v112, v52, v53
  v_cvt_pk_bf16_f32 v113, v54, v55
  v_mfma_f32_16x16x32_bf16 v[80:83], v[224:227], v[200:203], v[80:83]
  v_cvt_pk_bf16_f32 v118, v56, v57
  v_cvt_pk_bf16_f32 v119, v58, v59
  v_mfma_f32_16x16x32_bf16 v[84:87], v[224:227], v[204:207], v[84:87]
  v_cvt_pk_bf16_f32 v114, v60, v61
  v_cvt_pk_bf16_f32 v115, v62, v63
  v_mfma_f32_16x16x32_bf16 v[88:91], v[228:231], v[200:203], v[88:91]
  v_cvt_pk_bf16_f32 v136, v64, v65
  v_cvt_pk_bf16_f32 v137, v66, v67
  v_mfma_f32_16x16x32_bf16 v[92:95], v[228:231], v[204:207], v[92:95]
  v_cvt_pk_bf16_f32 v120, v68, v69
  v_cvt_pk_bf16_f32 v121, v70, v71
  v_mfma_f32_16x16x32_bf16 v[96:99], v[232:235], v[200:203], v[96:99]
  v_mov_b32 v170, 0
  v_mov_b32 v171, 0
  v_mfma_f32_16x16x32_bf16 v[100:103], v[232:235], v[204:207], v[100:103]
  v_mov_b32 v174, 0
  v_mov_b32 v175, 0
  v_mfma_f32_16x16x32_bf16 v[104:107], v[236:239], v[200:203], v[104:107]
  v_permlane16_swap_b32 v116, v112
  v_permlane16_swap_b32 v117, v113
  v_mfma_f32_16x16x32_bf16 v[108:111], v[236:239], v[204:207], v[108:111]
  v_permlane16_swap_b32 v118, v114
  v_permlane16_swap_b32 v119, v115
  ds_read_b32 v1, v32 offset:28
  v_permlane16_swap_b32 v136, v120
  v_permlane16_swap_b32 v137, v121
  v_mov_b32 v122, 0
  v_mov_b32 v123, 0
  s_waitcnt lgkmcnt(0)
  v_mfma_f32_32x32x16_bf16 v[208:223], v[152:155], v[112:115], 0
  v_permlane16_swap_b32 v72, v76
  v_permlane16_swap_b32 v73, v77
  v_permlane16_swap_b32 v74, v78
  v_permlane16_swap_b32 v75, v79
  v_cvt_pk_bf16_f32 v124, v80, v81
  v_cvt_pk_bf16_f32 v125, v82, v83
  v_mfma_f32_32x32x16_bf16 v[224:239], v[156:159], v[112:115], 0
  v_cvt_pk_bf16_f32 v128, v84, v85
  v_cvt_pk_bf16_f32 v129, v86, v87
  v_cvt_pk_bf16_f32 v126, v88, v89
  v_cvt_pk_bf16_f32 v127, v90, v91
  v_cvt_pk_bf16_f32 v130, v92, v93
  v_cvt_pk_bf16_f32 v131, v94, v95
  v_mfma_f32_32x32x16_bf16 v[208:223], v[160:163], v[116:119], v[208:223]
  v_cvt_pk_bf16_f32 v196, v96, v97
  v_cvt_pk_bf16_f32 v197, v98, v99
  v_cvt_pk_bf16_f32 v200, v100, v101
  v_cvt_pk_bf16_f32 v201, v102, v103
  v_cvt_pk_bf16_f32 v198, v104, v105
  v_cvt_pk_bf16_f32 v199, v106, v107
  v_mfma_f32_32x32x16_bf16 v[224:239], v[164:167], v[116:119], v[224:239]
  v_cvt_pk_bf16_f32 v202, v108, v109
  v_cvt_pk_bf16_f32 v203, v110, v111
  v_mov_b32 v134, 0
  v_mov_b32 v135, 0
  v_mov_b32 v206, 0x3f80
  v_mov_b32 v207, 0
  v_mfma_f32_32x32x16_bf16 v[208:223], v[168:171], v[120:123], v[208:223]
  v_mov_b32 v204, v136
  v_mov_b32 v205, v137
  v_cvt_pk_bf16_f32 v132, v72, v73
  v_cvt_pk_bf16_f32 v133, v74, v75
  v_permlane16_swap_b32 v124, v128
  v_permlane16_swap_b32 v125, v129
  v_mfma_f32_32x32x16_bf16 v[224:239], v[172:175], v[120:123], v[224:239]
  v_permlane16_swap_b32 v126, v130
  v_permlane16_swap_b32 v127, v131
  v_permlane16_swap_b32 v196, v200
  v_permlane16_swap_b32 v197, v201
  v_permlane16_swap_b32 v198, v202
  v_permlane16_swap_b32 v199, v203
  ds_write_b64 v12, v[76:77]
  s_mov_b64 exec, 1
  ds_add_u32 v32, v33 offset:32
  s_mov_b64 exec, -1
  ds_write_b128 v23, v[196:199]
  ds_write_b128 v24, v[200:203]
  ds_write_b128 v25, v[204:207]
  v_max3_f32 v100, v208, v209, v210
  v_min3_f32 v102, v208, v209, v210
  v_max3_f32 v100, v100, v211, v212
  v_min3_f32 v102, v102, v211, v212
  v_max3_f32 v100, v100, v213, v214
  v_min3_f32 v102, v102, v213, v214
  v_max3_f32 v100, v100, v215, v216
  v_min3_f32 v102, v102, v215, v216
  v_max3_f32 v100, v100, v217, v218
  v_min3_f32 v102, v102, v217, v218
  v_max3_f32 v100, v100, v219, v220
  v_min3_f32 v102, v102, v219, v220
  v_max3_f32 v100, v100, v221, v222
  v_min3_f32 v102, v102, v221, v222
  v_max3_f32 v100, v100, v223, v224
  v_min3_f32 v102, v102, v223, v224
  v_max3_f32 v100, v100, v225, v226
  v_min3_f32 v102, v102, v225, v226
  v_max_f32 v100, v100, v227
  v_min_f32 v102, v102, v227
  v_mul_f32 v101, s24, v100
  v_mul_f32 v103, s26, v102
  v_mul_f32 v100, s24, v100
  v_mul_f32 v102, s26, v102
  v_pk_fma_f32 v[80:81], v[208:209], s[24:25], v[102:103]
  v_pk_fma_f32 v[208:209], v[208:209], s[26:27], v[100:101]
  v_pk_fma_f32 v[82:83], v[210:211], s[24:25], v[102:103]
  v_pk_fma_f32 v[210:211], v[210:211], s[26:27], v[100:101]
  v_pk_fma_f32 v[84:85], v[212:213], s[24:25], v[102:103]
  v_pk_fma_f32 v[212:213], v[212:213], s[26:27], v[100:101]
  v_pk_fma_f32 v[86:87], v[214:215], s[24:25], v[102:103]
  v_pk_fma_f32 v[214:215], v[214:215], s[26:27], v[100:101]
  v_pk_fma_f32 v[88:89], v[216:217], s[24:25], v[102:103]
  v_pk_fma_f32 v[216:217], v[216:217], s[26:27], v[100:101]
  v_pk_fma_f32 v[90:91], v[218:219], s[24:25], v[102:103]
  v_pk_fma_f32 v[218:219], v[218:219], s[26:27], v[100:101]
  v_pk_fma_f32 v[92:93], v[220:221], s[24:25], v[102:103]
  v_pk_fma_f32 v[220:221], v[220:221], s[26:27], v[100:101]
  v_pk_fma_f32 v[94:95], v[222:223], s[24:25], v[102:103]
  v_pk_fma_f32 v[222:223], v[222:223], s[26:27], v[100:101]
  v_pk_fma_f32 v[96:97], v[224:225], s[24:25], v[102:103]
  v_pk_fma_f32 v[224:225], v[224:225], s[26:27], v[100:101]
  v_pk_fma_f32 v[98:99], v[226:227], s[24:25], v[102:103]
  v_pk_fma_f32 v[226:227], v[226:227], s[26:27], v[100:101]
  v_mfma_f32_32x32x16_bf16 v[48:63], v[152:155], v[124:127], 0
  v_exp_f32 v208, v208
  v_exp_f32 v209, v209
  v_exp_f32 v80, v80
  v_exp_f32 v81, v81
  v_mfma_f32_32x32x16_bf16 v[64:79], v[156:159], v[124:127], 0
  v_exp_f32 v210, v210
  v_exp_f32 v211, v211
  v_exp_f32 v82, v82
  v_exp_f32 v83, v83
  v_pk_add_f32 v[104:105], v[208:209], v[210:211]
  v_pk_add_f32 v[106:107], v[80:81], v[82:83]
  v_mfma_f32_32x32x16_bf16 v[48:63], v[160:163], v[128:131], v[48:63]
  v_exp_f32 v212, v212
  v_exp_f32 v213, v213
  v_exp_f32 v84, v84
  v_exp_f32 v85, v85
  v_pk_add_f32 v[104:105], v[104:105], v[212:213]
  v_pk_add_f32 v[106:107], v[106:107], v[84:85]
  v_mfma_f32_32x32x16_bf16 v[64:79], v[164:167], v[128:131], v[64:79]
  v_exp_f32 v214, v214
  v_exp_f32 v215, v215
  v_exp_f32 v86, v86
  v_exp_f32 v87, v87
  v_pk_add_f32 v[104:105], v[104:105], v[214:215]
  v_pk_add_f32 v[106:107], v[106:107], v[86:87]
  v_mfma_f32_32x32x16_bf16 v[48:63], v[168:171], v[132:135], v[48:63]
  v_exp_f32 v216, v216
  v_exp_f32 v217, v217
  v_exp_f32 v88, v88
  v_exp_f32 v89, v89
  v_pk_add_f32 v[104:105], v[104:105], v[216:217]
  v_pk_add_f32 v[106:107], v[106:107], v[88:89]
  v_mfma_f32_32x32x16_bf16 v[64:79], v[172:175], v[132:135], v[64:79]
  v_exp_f32 v218, v218
  v_exp_f32 v219, v219
  v_exp_f32 v90, v90
  v_exp_f32 v91, v91
  v_pk_add_f32 v[104:105], v[104:105], v[218:219]
  v_pk_add_f32 v[106:107], v[106:107], v[90:91]
  v_exp_f32 v220, v220
  v_exp_f32 v221, v221
  v_exp_f32 v92, v92
  v_exp_f32 v93, v93
  v_pk_add_f32 v[104:105], v[104:105], v[220:221]
  v_pk_add_f32 v[106:107], v[106:107], v[92:93]
  v_exp_f32 v222, v222
  v_exp_f32 v223, v223
  v_exp_f32 v94, v94
  v_exp_f32 v95, v95
  v_pk_add_f32 v[104:105], v[104:105], v[222:223]
  v_pk_add_f32 v[106:107], v[106:107], v[94:95]
  v_exp_f32 v224, v224
  v_exp_f32 v225, v225
  v_exp_f32 v96, v96
  v_exp_f32 v97, v97
  v_pk_add_f32 v[104:105], v[104:105], v[224:225]
  v_pk_add_f32 v[106:107], v[106:107], v[96:97]
  v_exp_f32 v226, v226
  v_exp_f32 v227, v227
  v_exp_f32 v98, v98
  v_exp_f32 v99, v99
  v_pk_add_f32 v[104:105], v[104:105], v[226:227]
  v_pk_add_f32 v[106:107], v[106:107], v[98:99]
  v_add_f32 v100, v104, v105
  v_add_f32 v102, v106, v107
  v_rcp_f32 v100, v100
  v_rcp_f32 v102, v102
  v_mov_b32 v101, v100
  v_mov_b32 v103, v102
  v_pk_mul_f32 v[208:209], v[208:209], v[100:101]
  v_pk_mul_f32 v[210:211], v[210:211], v[100:101]
  v_pk_mul_f32 v[212:213], v[212:213], v[100:101]
  v_pk_mul_f32 v[214:215], v[214:215], v[100:101]
  v_cvt_pk_bf16_f32 v176, v208, v209
  v_cvt_pk_bf16_f32 v177, v210, v211
  v_cvt_pk_bf16_f32 v178, v212, v213
  v_cvt_pk_bf16_f32 v179, v214, v215
  ds_write_b128 v18, v[176:179]
  v_pk_mul_f32 v[216:217], v[216:217], v[100:101]
  v_pk_mul_f32 v[218:219], v[218:219], v[100:101]
  v_pk_mul_f32 v[220:221], v[220:221], v[100:101]
  v_pk_mul_f32 v[222:223], v[222:223], v[100:101]
  v_cvt_pk_bf16_f32 v180, v216, v217
  v_cvt_pk_bf16_f32 v181, v218, v219
  v_cvt_pk_bf16_f32 v182, v220, v221
  v_cvt_pk_bf16_f32 v183, v222, v223
  ds_write_b128 v19, v[180:183]
  v_pk_mul_f32 v[224:225], v[224:225], v[100:101]
  v_pk_mul_f32 v[226:227], v[226:227], v[100:101]
  v_pk_mul_f32 v[80:81], v[80:81], v[102:103]
  v_pk_mul_f32 v[82:83], v[82:83], v[102:103]
  v_cvt_pk_bf16_f32 v184, v224, v225
  v_cvt_pk_bf16_f32 v185, v226, v227
  v_cvt_pk_bf16_f32 v186, v80, v81
  v_cvt_pk_bf16_f32 v187, v82, v83
  ds_write_b128 v20, v[184:187]
  v_pk_mul_f32 v[84:85], v[84:85], v[102:103]
  v_pk_mul_f32 v[86:87], v[86:87], v[102:103]
  v_pk_mul_f32 v[88:89], v[88:89], v[102:103]
  v_pk_mul_f32 v[90:91], v[90:91], v[102:103]
  v_cvt_pk_bf16_f32 v188, v84, v85
  v_cvt_pk_bf16_f32 v189, v86, v87
  v_cvt_pk_bf16_f32 v190, v88, v89
  v_cvt_pk_bf16_f32 v191, v90, v91
  ds_write_b128 v21, v[188:191]
  v_pk_mul_f32 v[92:93], v[92:93], v[102:103]
  v_pk_mul_f32 v[94:95], v[94:95], v[102:103]
  v_pk_mul_f32 v[96:97], v[96:97], v[102:103]
  v_pk_mul_f32 v[98:99], v[98:99], v[102:103]
  v_cvt_pk_bf16_f32 v192, v92, v93
  v_cvt_pk_bf16_f32 v193, v94, v95
  v_cvt_pk_bf16_f32 v194, v96, v97
  v_cvt_pk_bf16_f32 v195, v98, v99
  ds_write_b128 v22, v[192:195]
  s_mov_b64 exec, 1
  ds_add_u32 v32, v33 offset:0
  s_mov_b64 exec, -1
  s_mov_b64 exec, s[96:97]
  s_cbranch_execz NH8
  buffer_store_dword v1, v33, s[8:11], s98 offen offset:128 sc1
NH8:
  s_mov_b64 exec, -1
W9:
  ds_read_b32 v40, v32 offset:0
  s_sub_u32 s35, s35, 1
  s_cmp_lt_i32 s35, 0
  s_cbranch_scc1 W10
  s_waitcnt lgkmcnt(0)
  v_readfirstlane_b32 s34, v40
  s_nop 0
  s_cmp_ge_u32 s34, 4
  s_cbranch_scc0 W9
W10:
  ds_read_b64_tr_b16 v[112:113], v26 offset:0
  ds_read_b64_tr_b16 v[114:115], v27 offset:0
  ds_read_b64_tr_b16 v[116:117], v28 offset:0
  ds_read_b64_tr_b16 v[118:119], v29 offset:0
  ds_read_b64_tr_b16 v[120:121], v26 offset:2048
  ds_read_b64_tr_b16 v[122:123], v27 offset:2048
  ds_read_b64_tr_b16 v[124:125], v28 offset:2048
  ds_read_b64_tr_b16 v[126:127], v29 offset:2048
  ds_read_b64_tr_b16 v[128:129], v26 offset:4096
  ds_read_b64_tr_b16 v[130:131], v27 offset:4096
  ds_read_b64_tr_b16 v[132:133], v28 offset:4096
  ds_read_b64_tr_b16 v[134:135], v29 offset:4096
  ds_read_b64_tr_b16 v[136:137], v26 offset:6144
  ds_read_b64_tr_b16 v[138:139], v27 offset:6144
  ds_read_b64_tr_b16 v[140:141], v28 offset:6144
  ds_read_b64_tr_b16 v[142:143], v29 offset:6144
  s_waitcnt lgkmcnt(12)
  v_mfma_f32_32x32x16_bf16 v[208:223], v[112:115], v[116:119], 0
  ds_read_b64_tr_b16 v[144:145], v26 offset:8192
  ds_read_b64_tr_b16 v[146:147], v27 offset:8192
  ds_read_b64_tr_b16 v[148:149], v28 offset:8192
  ds_read_b64_tr_b16 v[150:151], v29 offset:8192
  s_waitcnt lgkmcnt(12)
  v_mfma_f32_32x32x16_bf16 v[208:223], v[120:123], v[124:127], v[208:223]
  ds_read_b64_tr_b16 v[152:153], v26 offset:10240
  ds_read_b64_tr_b16 v[154:155], v27 offset:10240
  ds_read_b64_tr_b16 v[156:157], v28 offset:10240
  ds_read_b64_tr_b16 v[158:159], v29 offset:10240
  s_waitcnt lgkmcnt(12)
  v_mfma_f32_32x32x16_bf16 v[208:223], v[128:131], v[132:135], v[208:223]
  ds_read_b64_tr_b16 v[160:161], v26 offset:12288
  ds_read_b64_tr_b16 v[162:163], v27 offset:12288
  ds_read_b64_tr_b16 v[164:165], v28 offset:12288
  ds_read_b64_tr_b16 v[166:167], v29 offset:12288
  s_waitcnt lgkmcnt(12)
  v_mfma_f32_32x32x16_bf16 v[208:223], v[136:139], v[140:143], v[208:223]
  ds_read_b64_tr_b16 v[168:169], v26 offset:14336
  ds_read_b64_tr_b16 v[170:171], v27 offset:14336
  ds_read_b64_tr_b16 v[172:173], v28 offset:14336
  ds_read_b64_tr_b16 v[174:175], v29 offset:14336
  s_waitcnt lgkmcnt(12)
  v_mfma_f32_32x32x16_bf16 v[208:223], v[144:147], v[148:151], v[208:223]
  ds_read_b32 v40, v32 offset:4
  s_waitcnt lgkmcnt(9)
  v_mfma_f32_32x32x16_bf16 v[208:223], v[152:155], v[156:159], v[208:223]
  s_waitcnt lgkmcnt(5)
  v_mfma_f32_32x32x16_bf16 v[208:223], v[160:163], v[164:167], v[208:223]
  s_waitcnt lgkmcnt(1)
  v_mfma_f32_32x32x16_bf16 v[208:223], v[168:171], v[172:175], v[208:223]
  v_mov_b32 v2, v240
  v_mov_b32 v3, v241
  v_add_u32 v4, 51200, v240
  s_waitcnt lgkmcnt(0)
  v_readfirstlane_b32 s49, v40
  s_nop 6
  v_cvt_pk_bf16_f32 v176, v208, v209
  v_cvt_pk_bf16_f32 v177, v210, v211
  v_cvt_pk_bf16_f32 v178, v212, v213
  v_cvt_pk_bf16_f32 v179, v214, v215
  v_min_u32 v176, -2, v176
  v_min_u32 v177, -2, v177
  v_min_u32 v178, -2, v178
  v_min_u32 v179, -2, v179
  s_mov_b32 exec_lo, 0xffffff
  s_mov_b32 exec_hi, s47
  buffer_store_dwordx4 v[176:179], v31, s[8:11], s46 offen offset:0 sc1
  s_mov_b64 exec, -1
  v_cvt_pk_bf16_f32 v180, v216, v217
  v_cvt_pk_bf16_f32 v181, v218, v219
  v_cvt_pk_bf16_f32 v182, v220, v221
  v_cvt_pk_bf16_f32 v183, v222, v223
  v_min_u32 v180, -2, v180
  v_min_u32 v181, -2, v181
  v_min_u32 v182, -2, v182
  v_min_u32 v183, -2, v183
  s_mov_b32 exec_lo, s47
  s_mov_b32 exec_hi, s47
  buffer_store_dwordx4 v[180:183], v31, s[8:11], s46 offen offset:384 sc1
  s_mov_b64 exec, -1
  s_mov_b32 s51, 0
  s_andn2_b32 s49, s49, s51
  s_or_b32 s51, s51, s49
  s_bitcmp0_b32 s49, 0
  s_cbranch_scc1 G111
  buffer_load_dwordx4 v[112:115], v34, s[8:11], s20 offen offset:0 sc1
  buffer_load_dwordx4 v[116:119], v34, s[8:11], s20 offen offset:1024 sc1
  buffer_load_dwordx4 v[120:123], v34, s[8:11], s20 offen offset:2048 sc1
  buffer_load_dwordx4 v[124:127], v35, s[8:11], s20 offen sc1
G111:
  s_bitcmp0_b32 s49, 1
  s_cbranch_scc1 G112
  buffer_load_dwordx4 v[128:131], v34, s[8:11], s21 offen offset:0 sc1
  buffer_load_dwordx4 v[132:135], v34, s[8:11], s21 offen offset:1024 sc1
  buffer_load_dwordx4 v[136:139], v34, s[8:11], s21 offen offset:2048 sc1
  buffer_load_dwordx4 v[140:143], v35, s[8:11], s21 offen sc1
G112:
  s_bitcmp0_b32 s49, 2
  s_cbranch_scc1 G113
  buffer_load_dwordx4 v[144:147], v34, s[8:11], s22 offen offset:0 sc1
  buffer_load_dwordx4 v[148:151], v34, s[8:11], s22 offen offset:1024 sc1
  buffer_load_dwordx4 v[152:155], v34, s[8:11], s22 offen offset:2048 sc1
  buffer_load_dwordx4 v[156:159], v35, s[8:11], s22 offen sc1
G113:
  s_bitcmp0_b32 s49, 3
  s_cbranch_scc1 G114
  buffer_load_dwordx4 v[160:163], v34, s[8:11], s23 offen offset:0 sc1
  buffer_load_dwordx4 v[164:167], v34, s[8:11], s23 offen offset:1024 sc1
  buffer_load_dwordx4 v[168:171], v34, s[8:11], s23 offen offset:2048 sc1
  buffer_load_dwordx4 v[172:175], v35, s[8:11], s23 offen sc1
G114:
  v_cvt_pk_bf16_f32 v80, v48, v49
  v_cvt_pk_bf16_f32 v81, v50, v51
  v_cvt_pk_bf16_f32 v82, v52, v53
  v_cvt_pk_bf16_f32 v83, v54, v55
  v_cvt_pk_bf16_f32 v84, v56, v57
  v_cvt_pk_bf16_f32 v85, v58, v59
  v_cvt_pk_bf16_f32 v86, v60, v61
  v_cvt_pk_bf16_f32 v87, v62, v63
  v_cvt_pk_bf16_f32 v88, v64, v65
  v_cvt_pk_bf16_f32 v89, v66, v67
  v_lshlrev_b32 v48, 16, v80
  v_and_b32 v49, 0xffff0000, v80
  v_lshlrev_b32 v50, 16, v81
  v_and_b32 v51, 0xffff0000, v81
  v_lshlrev_b32 v52, 16, v82
  v_and_b32 v53, 0xffff0000, v82
  v_lshlrev_b32 v54, 16, v83
  v_and_b32 v55, 0xffff0000, v83
  v_lshlrev_b32 v56, 16, v84
  v_and_b32 v57, 0xffff0000, v84
  v_lshlrev_b32 v58, 16, v85
  v_and_b32 v59, 0xffff0000, v85
  v_lshlrev_b32 v60, 16, v86
  v_and_b32 v61, 0xffff0000, v86
  v_lshlrev_b32 v62, 16, v87
  v_and_b32 v63, 0xffff0000, v87
  v_lshlrev_b32 v64, 16, v88
  v_and_b32 v65, 0xffff0000, v88
  v_lshlrev_b32 v66, 16, v89
  v_and_b32 v67, 0xffff0000, v89
  v_max3_f32 v100, v48, v49, v50
  v_min3_f32 v102, v48, v49, v50
  v_max3_f32 v100, v100, v51, v52
  v_min3_f32 v102, v102, v51, v52
  v_max3_f32 v100, v100, v53, v54
  v_min3_f32 v102, v102, v53, v54
  v_max3_f32 v100, v100, v55, v56
  v_min3_f32 v102, v102, v55, v56
  v_max3_f32 v100, v100, v57, v58
  v_min3_f32 v102, v102, v57, v58
  v_max3_f32 v100, v100, v59, v60
  v_min3_f32 v102, v102, v59, v60
  v_max3_f32 v100, v100, v61, v62
  v_min3_f32 v102, v102, v61, v62
  v_max3_f32 v100, v100, v63, v64
  v_min3_f32 v102, v102, v63, v64
  v_max3_f32 v100, v100, v65, v66
  v_min3_f32 v102, v102, v65, v66
  v_max_f32 v100, v100, v67
  v_min_f32 v102, v102, v67
  v_mul_f32 v101, s24, v100
  v_mul_f32 v103, s26, v102
  v_mul_f32 v100, s24, v100
  v_mul_f32 v102, s26, v102
  v_pk_fma_f32 v[80:81], v[48:49], s[24:25], v[102:103]
  v_pk_fma_f32 v[48:49], v[48:49], s[26:27], v[100:101]
  v_pk_fma_f32 v[82:83], v[50:51], s[24:25], v[102:103]
  v_pk_fma_f32 v[50:51], v[50:51], s[26:27], v[100:101]
  v_pk_fma_f32 v[84:85], v[52:53], s[24:25], v[102:103]
  v_pk_fma_f32 v[52:53], v[52:53], s[26:27], v[100:101]
  v_pk_fma_f32 v[86:87], v[54:55], s[24:25], v[102:103]
  v_pk_fma_f32 v[54:55], v[54:55], s[26:27], v[100:101]
  v_pk_fma_f32 v[88:89], v[56:57], s[24:25], v[102:103]
  v_pk_fma_f32 v[56:57], v[56:57], s[26:27], v[100:101]
  v_pk_fma_f32 v[90:91], v[58:59], s[24:25], v[102:103]
  v_pk_fma_f32 v[58:59], v[58:59], s[26:27], v[100:101]
  v_pk_fma_f32 v[92:93], v[60:61], s[24:25], v[102:103]
  v_pk_fma_f32 v[60:61], v[60:61], s[26:27], v[100:101]
  v_pk_fma_f32 v[94:95], v[62:63], s[24:25], v[102:103]
  v_pk_fma_f32 v[62:63], v[62:63], s[26:27], v[100:101]
  v_pk_fma_f32 v[96:97], v[64:65], s[24:25], v[102:103]
  v_pk_fma_f32 v[64:65], v[64:65], s[26:27], v[100:101]
  v_pk_fma_f32 v[98:99], v[66:67], s[24:25], v[102:103]
  v_pk_fma_f32 v[66:67], v[66:67], s[26:27], v[100:101]
  v_exp_f32 v48, v48
  v_exp_f32 v49, v49
  v_exp_f32 v80, v80
  v_exp_f32 v81, v81
  v_exp_f32 v50, v50
  v_exp_f32 v51, v51
  v_exp_f32 v82, v82
  v_exp_f32 v83, v83
  v_pk_add_f32 v[104:105], v[48:49], v[50:51]
  v_pk_add_f32 v[106:107], v[80:81], v[82:83]
  v_exp_f32 v52, v52
  v_exp_f32 v53, v53
  v_exp_f32 v84, v84
  v_exp_f32 v85, v85
  v_pk_add_f32 v[104:105], v[104:105], v[52:53]
  v_pk_add_f32 v[106:107], v[106:107], v[84:85]
  v_exp_f32 v54, v54
  v_exp_f32 v55, v55
  v_exp_f32 v86, v86
  v_exp_f32 v87, v87
  v_pk_add_f32 v[104:105], v[104:105], v[54:55]
  v_pk_add_f32 v[106:107], v[106:107], v[86:87]
  v_exp_f32 v56, v56
  v_exp_f32 v57, v57
  v_exp_f32 v88, v88
  v_exp_f32 v89, v89
  v_pk_add_f32 v[104:105], v[104:105], v[56:57]
  v_pk_add_f32 v[106:107], v[106:107], v[88:89]
  v_exp_f32 v58, v58
  v_exp_f32 v59, v59
  v_exp_f32 v90, v90
  v_exp_f32 v91, v91
  v_pk_add_f32 v[104:105], v[104:105], v[58:59]
  v_pk_add_f32 v[106:107], v[106:107], v[90:91]
  v_exp_f32 v60, v60
  v_exp_f32 v61, v61
  v_exp_f32 v92, v92
  v_exp_f32 v93, v93
  v_pk_add_f32 v[104:105], v[104:105], v[60:61]
  v_pk_add_f32 v[106:107], v[106:107], v[92:93]
  v_exp_f32 v62, v62
  v_exp_f32 v63, v63
  v_exp_f32 v94, v94
  v_exp_f32 v95, v95
  v_pk_add_f32 v[104:105], v[104:105], v[62:63]
  v_pk_add_f32 v[106:107], v[106:107], v[94:95]
  v_exp_f32 v64, v64
  v_exp_f32 v65, v65
  v_exp_f32 v96, v96
  v_exp_f32 v97, v97
  v_pk_add_f32 v[104:105], v[104:105], v[64:65]
  v_pk_add_f32 v[106:107], v[106:107], v[96:97]
  ds_read_b32 v38, v32 offset:4
  v_exp_f32 v66, v66
  v_exp_f32 v67, v67
  v_exp_f32 v98, v98
  v_exp_f32 v99, v99
  v_pk_add_f32 v[104:105], v[104:105], v[66:67]
  v_pk_add_f32 v[106:107], v[106:107], v[98:99]
  v_add_f32 v100, v104, v105
  v_add_f32 v102, v106, v107
  v_rcp_f32 v100, v100
  v_rcp_f32 v102, v102
  v_mov_b32 v101, v100
  v_mov_b32 v103, v102
  v_pk_mul_f32 v[48:49], v[48:49], v[100:101]
  v_pk_mul_f32 v[50:51], v[50:51], v[100:101]
  v_pk_mul_f32 v[52:53], v[52:53], v[100:101]
  v_pk_mul_f32 v[54:55], v[54:55], v[100:101]
  v_cvt_pk_bf16_f32 v184, v48, v49
  v_cvt_pk_bf16_f32 v185, v50, v51
  v_cvt_pk_bf16_f32 v186, v52, v53
  v_cvt_pk_bf16_f32 v187, v54, v55
  v_pk_mul_f32 v[56:57], v[56:57], v[100:101]
  v_pk_mul_f32 v[58:59], v[58:59], v[100:101]
  v_pk_mul_f32 v[60:61], v[60:61], v[100:101]
  v_pk_mul_f32 v[62:63], v[62:63], v[100:101]
  v_cvt_pk_bf16_f32 v188, v56, v57
  v_cvt_pk_bf16_f32 v189, v58, v59
  v_cvt_pk_bf16_f32 v190, v60, v61
  v_cvt_pk_bf16_f32 v191, v62, v63
  v_pk_mul_f32 v[64:65], v[64:65], v[100:101]
  v_pk_mul_f32 v[66:67], v[66:67], v[100:101]
  v_pk_mul_f32 v[80:81], v[80:81], v[102:103]
  v_pk_mul_f32 v[82:83], v[82:83], v[102:103]
  v_cvt_pk_bf16_f32 v192, v64, v65
  v_cvt_pk_bf16_f32 v193, v66, v67
  v_cvt_pk_bf16_f32 v194, v80, v81
  v_cvt_pk_bf16_f32 v195, v82, v83
  v_pk_mul_f32 v[84:85], v[84:85], v[102:103]
  v_pk_mul_f32 v[86:87], v[86:87], v[102:103]
  v_pk_mul_f32 v[88:89], v[88:89], v[102:103]
  v_pk_mul_f32 v[90:91], v[90:91], v[102:103]
  v_cvt_pk_bf16_f32 v196, v84, v85
  v_cvt_pk_bf16_f32 v197, v86, v87
  v_cvt_pk_bf16_f32 v198, v88, v89
  v_cvt_pk_bf16_f32 v199, v90, v91
  v_pk_mul_f32 v[92:93], v[92:93], v[102:103]
  v_pk_mul_f32 v[94:95], v[94:95], v[102:103]
  v_pk_mul_f32 v[96:97], v[96:97], v[102:103]
  v_pk_mul_f32 v[98:99], v[98:99], v[102:103]
  v_cvt_pk_bf16_f32 v200, v92, v93
  v_cvt_pk_bf16_f32 v201, v94, v95
  v_cvt_pk_bf16_f32 v202, v96, v97
  v_cvt_pk_bf16_f32 v203, v98, v99
  s_waitcnt lgkmcnt(0)
  v_readfirstlane_b32 s49, v38
  s_nop 0
  s_andn2_b32 s49, s49, s51
  s_or_b32 s51, s51, s49
  s_bitcmp0_b32 s49, 0
  s_cbranch_scc1 G115
  buffer_load_dwordx4 v[112:115], v34, s[8:11], s20 offen offset:0 sc1
  buffer_load_dwordx4 v[116:119], v34, s[8:11], s20 offen offset:1024 sc1
  buffer_load_dwordx4 v[120:123], v34, s[8:11], s20 offen offset:2048 sc1
  buffer_load_dwordx4 v[124:127], v35, s[8:11], s20 offen sc1
G115:
  s_bitcmp0_b32 s49, 1
  s_cbranch_scc1 G116
  buffer_load_dwordx4 v[128:131], v34, s[8:11], s21 offen offset:0 sc1
  buffer_load_dwordx4 v[132:135], v34, s[8:11], s21 offen offset:1024 sc1
  buffer_load_dwordx4 v[136:139], v34, s[8:11], s21 offen offset:2048 sc1
  buffer_load_dwordx4 v[140:143], v35, s[8:11], s21 offen sc1
G116:
  s_bitcmp0_b32 s49, 2
  s_cbranch_scc1 G117
  buffer_load_dwordx4 v[144:147], v34, s[8:11], s22 offen offset:0 sc1
  buffer_load_dwordx4 v[148:151], v34, s[8:11], s22 offen offset:1024 sc1
  buffer_load_dwordx4 v[152:155], v34, s[8:11], s22 offen offset:2048 sc1
  buffer_load_dwordx4 v[156:159], v35, s[8:11], s22 offen sc1
G117:
  s_bitcmp0_b32 s49, 3
  s_cbranch_scc1 G118
  buffer_load_dwordx4 v[160:163], v34, s[8:11], s23 offen offset:0 sc1
  buffer_load_dwordx4 v[164:167], v34, s[8:11], s23 offen offset:1024 sc1
  buffer_load_dwordx4 v[168:171], v34, s[8:11], s23 offen offset:2048 sc1
  buffer_load_dwordx4 v[172:175], v35, s[8:11], s23 offen sc1
G118:
  s_cmp_eq_u32 s51, 15
  s_cbranch_scc1 L_G1D
L_G1W:
  ds_read_b32 v38, v32 offset:4
  s_waitcnt lgkmcnt(0)
  v_readfirstlane_b32 s49, v38
  s_nop 0
  s_cmp_eq_u32 s49, s51
  s_cbranch_scc1 L_G1W
  s_andn2_b32 s49, s49, s51
  s_or_b32 s51, s51, s49
  s_bitcmp0_b32 s49, 0
  s_cbranch_scc1 G119
  buffer_load_dwordx4 v[112:115], v34, s[8:11], s20 offen offset:0 sc1
  buffer_load_dwordx4 v[116:119], v34, s[8:11], s20 offen offset:1024 sc1
  buffer_load_dwordx4 v[120:123], v34, s[8:11], s20 offen offset:2048 sc1
  buffer_load_dwordx4 v[124:127], v35, s[8:11], s20 offen sc1
G119:
  s_bitcmp0_b32 s49, 1
  s_cbranch_scc1 G120
  buffer_load_dwordx4 v[128:131], v34, s[8:11], s21 offen offset:0 sc1
  buffer_load_dwordx4 v[132:135], v34, s[8:11], s21 offen offset:1024 sc1
  buffer_load_dwordx4 v[136:139], v34, s[8:11], s21 offen offset:2048 sc1
  buffer_load_dwordx4 v[140:143], v35, s[8:11], s21 offen sc1
G120:
  s_bitcmp0_b32 s49, 2
  s_cbranch_scc1 G121
  buffer_load_dwordx4 v[144:147], v34, s[8:11], s22 offen offset:0 sc1
  buffer_load_dwordx4 v[148:151], v34, s[8:11], s22 offen offset:1024 sc1
  buffer_load_dwordx4 v[152:155], v34, s[8:11], s22 offen offset:2048 sc1
  buffer_load_dwordx4 v[156:159], v35, s[8:11], s22 offen sc1
G121:
  s_bitcmp0_b32 s49, 3
  s_cbranch_scc1 G122
  buffer_load_dwordx4 v[160:163], v34, s[8:11], s23 offen offset:0 sc1
  buffer_load_dwordx4 v[164:167], v34, s[8:11], s23 offen offset:1024 sc1
  buffer_load_dwordx4 v[168:171], v34, s[8:11], s23 offen offset:2048 sc1
  buffer_load_dwordx4 v[172:175], v35, s[8:11], s23 offen sc1
G122:
  s_cmp_lg_u32 s51, 15
  s_cbranch_scc1 L_G1W
L_G1D:
  s_mov_b64 exec, 1
  ds_add_u32 v32, v33 offset:36
  s_mov_b64 exec, -1
  s_waitcnt vmcnt(0)
L_RED:
  v_mfma_f32_16x16x32_bf16 v[48:51], v[44:47], v[112:115], 0
  v_mfma_f32_16x16x32_bf16 v[52:55], v[44:47], v[116:119], 0
  v_mfma_f32_16x16x32_bf16 v[56:59], v[44:47], v[120:123], 0
  v_mfma_f32_16x16x32_bf16 v[60:63], v[44:47], v[124:127], 0
  v_mfma_f32_16x16x32_bf16 v[48:51], v[44:47], v[128:131], v[48:51]
  v_mfma_f32_16x16x32_bf16 v[52:55], v[44:47], v[132:135], v[52:55]
  v_mfma_f32_16x16x32_bf16 v[56:59], v[44:47], v[136:139], v[56:59]
  v_mfma_f32_16x16x32_bf16 v[60:63], v[44:47], v[140:143], v[60:63]
  v_mfma_f32_16x16x32_bf16 v[48:51], v[44:47], v[144:147], v[48:51]
  v_mfma_f32_16x16x32_bf16 v[52:55], v[44:47], v[148:151], v[52:55]
  v_mfma_f32_16x16x32_bf16 v[56:59], v[44:47], v[152:155], v[56:59]
  v_mfma_f32_16x16x32_bf16 v[60:63], v[44:47], v[156:159], v[60:63]
  v_mfma_f32_16x16x32_bf16 v[48:51], v[44:47], v[160:163], v[48:51]
  v_mfma_f32_16x16x32_bf16 v[52:55], v[44:47], v[164:167], v[52:55]
  v_mfma_f32_16x16x32_bf16 v[56:59], v[44:47], v[168:171], v[56:59]
  v_mfma_f32_16x16x32_bf16 v[60:63], v[44:47], v[172:175], v[60:63]
  s_nop 5
  v_cmp_u_f32 s[32:33], v48, v52
  s_nop 0
  v_cmp_u_f32 vcc, v56, v60
  s_nop 0
  s_or_b64 vcc, vcc, s[32:33]
  s_cbranch_vccnz L_RETRY1
L_RED_OK:
  v_cvt_pk_bf16_f32 v64, v48, v49
  v_cvt_pk_bf16_f32 v65, v50, v51
  v_cvt_pk_bf16_f32 v66, v52, v53
  v_cvt_pk_bf16_f32 v67, v54, v55
  v_cvt_pk_bf16_f32 v68, v56, v57
  v_cvt_pk_bf16_f32 v69, v58, v59
  v_cvt_pk_bf16_f32 v70, v60, v61
  v_cvt_pk_bf16_f32 v71, v62, v63
  s_mov_b32 exec_hi, 0
  ds_write_b64 v252, v[64:65] offset:0
  ds_write_b64 v252, v[66:67] offset:1024
  ds_write_b64 v252, v[68:69] offset:2048
  ds_write_b64 v252, v[70:71] offset:3072
  s_mov_b64 exec, 1
  ds_add_u32 v32, v33 offset:8
  s_mov_b64 exec, -1
W23:
  ds_read_b32 v38, v32 offset:8
  s_sub_u32 s35, s35, 1
  s_cmp_lt_i32 s35, 0
  s_cbranch_scc1 W24
  s_waitcnt lgkmcnt(0)
  v_readfirstlane_b32 s34, v38
  s_nop 0
  s_cmp_ge_u32 s34, 5
  s_cbranch_scc0 W23
W24:
  s_mov_b64 exec, s[96:97]
  s_cbranch_execz NH25
  buffer_store_dword v1, v33, s[8:11], s98 offen offset:256 sc1
NH25:
  s_mov_b64 exec, -1
  ds_read_b128 v[116:119], v36 offset:256
  ds_read_b128 v[112:115], v36 offset:0
  ds_read_b128 v[124:127], v36 offset:640
  ds_read_b128 v[120:123], v36 offset:384
  ds_read_b128 v[132:135], v36 offset:1024
  ds_read_b128 v[128:131], v36 offset:768
  ds_read_b128 v[140:143], v36 offset:1408
  ds_read_b128 v[136:139], v36 offset:1152
  ds_read_b128 v[148:151], v36 offset:1792
  ds_read_b128 v[144:147], v36 offset:1536
  ds_read_b32 v40, v32 offset:12
  ds_read_b32 v41, v32 offset:40
  s_waitcnt lgkmcnt(11)
  v_mfma_f32_32x32x16_bf16 v[64:79], v[116:119], v[184:187], 0
  s_waitcnt lgkmcnt(10)
  v_mfma_f32_32x32x16_bf16 v[48:63], v[112:115], v[184:187], 0
  s_waitcnt lgkmcnt(9)
  v_mfma_f32_32x32x16_bf16 v[64:79], v[124:127], v[188:191], v[64:79]
  s_waitcnt lgkmcnt(8)
  v_mfma_f32_32x32x16_bf16 v[48:63], v[120:123], v[188:191], v[48:63]
  s_waitcnt lgkmcnt(7)
  v_mfma_f32_32x32x16_bf16 v[64:79], v[132:135], v[192:195], v[64:79]
  s_waitcnt lgkmcnt(6)
  v_mfma_f32_32x32x16_bf16 v[48:63], v[128:131], v[192:195], v[48:63]
  s_waitcnt lgkmcnt(5)
  v_mfma_f32_32x32x16_bf16 v[64:79], v[140:143], v[196:199], v[64:79]
  s_waitcnt lgkmcnt(4)
  v_mfma_f32_32x32x16_bf16 v[48:63], v[136:139], v[196:199], v[48:63]
  s_waitcnt lgkmcnt(3)
  v_mfma_f32_32x32x16_bf16 v[64:79], v[148:151], v[200:203], v[64:79]
  s_waitcnt lgkmcnt(2)
  v_mfma_f32_32x32x16_bf16 v[48:63], v[144:147], v[200:203], v[48:63]
  s_waitcnt lgkmcnt(0)
  v_readfirstlane_b32 s49, v40
  v_readfirstlane_b32 s50, v41
  s_nop 6
  v_add_f32 v38, 0x358637bd, v68
  v_rcp_f32 v38, v38
  s_nop 0
  v_mov_b32 v39, v38
  v_pk_mul_f32 v[64:65], v[64:65], v[38:39]
  v_pk_mul_f32 v[66:67], v[66:67], v[38:39]
  v_cvt_pk_bf16_f32 v88, v64, v65
  v_cvt_pk_bf16_f32 v89, v66, v67
  v_min_u32 v88, -2, v88
  v_min_u32 v89, -2, v89
  buffer_store_dwordx2 v[88:89], v246, s[8:11], s7 offen offset:1024 sc1
  v_pk_mul_f32 v[48:49], v[48:49], v[38:39]
  v_pk_mul_f32 v[50:51], v[50:51], v[38:39]
  v_pk_mul_f32 v[52:53], v[52:53], v[38:39]
  v_pk_mul_f32 v[54:55], v[54:55], v[38:39]
  v_cvt_pk_bf16_f32 v80, v48, v49
  v_cvt_pk_bf16_f32 v81, v50, v51
  v_cvt_pk_bf16_f32 v82, v52, v53
  v_cvt_pk_bf16_f32 v83, v54, v55
  v_min_u32 v80, -2, v80
  v_min_u32 v81, -2, v81
  v_min_u32 v82, -2, v82
  v_min_u32 v83, -2, v83
  buffer_store_dwordx4 v[80:83], v37, s[8:11], s7 offen offset:0 sc1
  v_pk_mul_f32 v[56:57], v[56:57], v[38:39]
  v_pk_mul_f32 v[58:59], v[58:59], v[38:39]
  v_pk_mul_f32 v[60:61], v[60:61], v[38:39]
  v_pk_mul_f32 v[62:63], v[62:63], v[38:39]
  v_cvt_pk_bf16_f32 v84, v56, v57
  v_cvt_pk_bf16_f32 v85, v58, v59
  v_cvt_pk_bf16_f32 v86, v60, v61
  v_cvt_pk_bf16_f32 v87, v62, v63
  v_min_u32 v84, -2, v84
  v_min_u32 v85, -2, v85
  v_min_u32 v86, -2, v86
  v_min_u32 v87, -2, v87
  buffer_store_dwordx4 v[84:87], v37, s[8:11], s7 offen offset:512 sc1
  s_cmp_lg_u32 s49, 15
  s_cbranch_scc1 L_G2L
  s_add_u32 s33, s40, 0
  buffer_load_dwordx4 v[96:99], v2, s[8:11], s33 offen sc1
  s_add_u32 s33, s40, 17536
  buffer_load_dwordx4 v[100:103], v2, s[8:11], s33 offen sc1
  s_add_u32 s33, s40, 35072
  buffer_load_dwordx4 v[104:107], v2, s[8:11], s33 offen sc1
  s_add_u32 s33, s40, 52608
  buffer_load_dwordx4 v[108:111], v2, s[8:11], s33 offen sc1
  s_add_u32 s33, s40, 0
  buffer_load_dwordx2 v[112:113], v3, s[8:11], s33 offen offset:1024 sc1
  s_add_u32 s33, s40, 17536
  buffer_load_dwordx2 v[114:115], v3, s[8:11], s33 offen offset:1024 sc1
  s_add_u32 s33, s41, 0
  buffer_load_dwordx4 v[116:119], v2, s[8:11], s33 offen sc1
  s_add_u32 s33, s41, 17536
  buffer_load_dwordx4 v[120:123], v2, s[8:11], s33 offen sc1
  s_add_u32 s33, s41, 35072
  buffer_load_dwordx4 v[124:127], v2, s[8:11], s33 offen sc1
  s_add_u32 s33, s41, 52608
  buffer_load_dwordx4 v[128:131], v2, s[8:11], s33 offen sc1
  s_add_u32 s33, s41, 0
  buffer_load_dwordx2 v[132:133], v3, s[8:11], s33 offen offset:1024 sc1
  s_add_u32 s33, s41, 17536
  buffer_load_dwordx2 v[134:135], v3, s[8:11], s33 offen offset:1024 sc1
L_G2L:
  s_cmp_ge_u32 s50, 2
  s_cbranch_scc1 L_WOK
W26:
  ds_read_b32 v38, v32 offset:40
  s_sub_u32 s35, s35, 1
  s_cmp_lt_i32 s35, 0
  s_cbranch_scc1 W27
  s_waitcnt lgkmcnt(0)
  v_readfirstlane_b32 s34, v38
  s_nop 0
  s_cmp_ge_u32 s34, 2
  s_cbranch_scc0 W26
W27:
L_WOK:
  v_mov_b32 v31, v247
  v_mov_b32 v90, v248
  v_mov_b32 v91, v249
  v_mov_b32 v92, v250
  v_mov_b32 v93, v251
  ds_read_b32 v41, v253
  ds_read_b64 v[196:197], v31 offset:0
  ds_read_b64 v[198:199], v31 offset:8
  ds_read_b64 v[200:201], v31 offset:16
  ds_read_b64 v[202:203], v31 offset:24
  ds_read_b64 v[204:205], v31 offset:32
  ds_read_b128 v[8:11], v2 offset:0
  ds_read_b128 v[12:15], v2 offset:1024
  ds_read_b128 v[16:19], v2 offset:2048
  ds_read_b128 v[20:23], v2 offset:3072
  ds_read_b128 v[24:27], v2 offset:4096
  ds_read_b128 v[48:51], v2 offset:5120
  ds_read_b128 v[52:55], v2 offset:6144
  ds_read_b128 v[56:59], v2 offset:7168
  ds_read_b128 v[60:63], v2 offset:8192
  ds_read_b128 v[64:67], v2 offset:9216
  ds_read_b128 v[68:71], v2 offset:10240
  ds_read_b128 v[72:75], v2 offset:11264
  ds_read_b128 v[76:79], v2 offset:12288
  ds_read_b128 v[80:83], v2 offset:13312
  ds_read_b128 v[84:87], v2 offset:14336
  ds_read_b128 v[176:179], v2 offset:15360
  ds_read_b128 v[180:183], v2 offset:16384
  ds_read_b128 v[184:187], v2 offset:17408
  ds_read_b128 v[188:191], v2 offset:18432
  ds_read_b128 v[192:195], v2 offset:19456
  ds_read_b128 v[228:231], v2 offset:20480
  ds_read_b128 v[232:235], v2 offset:21504
  ds_read_b128 v[236:239], v2 offset:22528
  ds_read_b128 v[240:243], v2 offset:23552
  ds_read_b128 v[244:247], v2 offset:24576
  s_waitcnt lgkmcnt(15)
  v_cvt_pk_bf16_f32 v41, v41, v41
  v_and_b32 v41, 0xffff0000, v41
  v_mul_f32 v41, s24, v41
  v_exp_f32 v41, v41
  s_nop 0
  v_add_f32 v41, 1.0, v41
  v_rcp_f32 v41, v41
  s_nop 0
  v_cvt_pk_bf16_f32 v28, v41, v41
  v_and_b32 v28, 0xffff0000, v28
  v_sub_f32 v42, 1.0, v28
  v_cvt_pk_bf16_f32 v42, v42, v42
  v_and_b32 v42, 0xffff0000, v42
  v_mov_b32 v29, v28
  v_mov_b32 v43, v42
  v_lshlrev_b32 v208, 16, v196
  v_and_b32 v209, 0xffff0000, v196
  v_lshlrev_b32 v210, 16, v197
  v_and_b32 v211, 0xffff0000, v197
  v_lshlrev_b32 v212, 16, v198
  v_and_b32 v213, 0xffff0000, v198
  v_lshlrev_b32 v214, 16, v199
  v_and_b32 v215, 0xffff0000, v199
  v_lshlrev_b32 v216, 16, v200
  v_and_b32 v217, 0xffff0000, v200
  v_lshlrev_b32 v218, 16, v201
  v_and_b32 v219, 0xffff0000, v201
  v_lshlrev_b32 v220, 16, v202
  v_and_b32 v221, 0xffff0000, v202
  v_lshlrev_b32 v222, 16, v203
  v_and_b32 v223, 0xffff0000, v203
  v_lshlrev_b32 v224, 16, v204
  v_and_b32 v225, 0xffff0000, v204
  v_lshlrev_b32 v226, 16, v205
  v_and_b32 v227, 0xffff0000, v205
  v_pk_mul_f32 v[208:209], v[208:209], v[42:43]
  v_pk_mul_f32 v[210:211], v[210:211], v[42:43]
  v_pk_mul_f32 v[212:213], v[212:213], v[42:43]
  v_pk_mul_f32 v[214:215], v[214:215], v[42:43]
  v_pk_mul_f32 v[216:217], v[216:217], v[42:43]
  v_pk_mul_f32 v[218:219], v[218:219], v[42:43]
  v_pk_mul_f32 v[220:221], v[220:221], v[42:43]
  v_pk_mul_f32 v[222:223], v[222:223], v[42:43]
  v_pk_mul_f32 v[224:225], v[224:225], v[42:43]
  v_pk_mul_f32 v[226:227], v[226:227], v[42:43]
  s_cmp_lg_u32 s49, 15
  s_cbranch_scc1 L_G2W
L_G2D:
  s_add_u32 s33, s42, 0
  buffer_load_dwordx4 v[136:139], v2, s[8:11], s33 offen sc1
  s_add_u32 s33, s42, 17536
  buffer_load_dwordx4 v[140:143], v2, s[8:11], s33 offen sc1
  s_add_u32 s33, s42, 35072
  buffer_load_dwordx4 v[144:147], v2, s[8:11], s33 offen sc1
  s_add_u32 s33, s42, 52608
  buffer_load_dwordx4 v[148:151], v2, s[8:11], s33 offen sc1
  s_add_u32 s33, s42, 0
  buffer_load_dwordx2 v[152:153], v3, s[8:11], s33 offen offset:1024 sc1
  s_add_u32 s33, s42, 17536
  buffer_load_dwordx2 v[154:155], v3, s[8:11], s33 offen offset:1024 sc1
  s_mov_b32 s52, 0
L_G2X:
  s_waitcnt vmcnt(12)
  s_bitcmp1_b32 s52, 0
  s_cbranch_scc1 L_PW0
L_PWR0:
  v_max3_u32 v38, v96, v97, v98
  v_max3_u32 v38, v38, v99, v100
  v_max3_u32 v38, v38, v101, v102
  v_max3_u32 v38, v38, v103, v104
  v_max3_u32 v38, v38, v105, v106
  v_max3_u32 v38, v38, v107, v108
  v_max3_u32 v38, v38, v109, v110
  v_max3_u32 v38, v38, v111, v112
  v_max3_u32 v38, v38, v113, v114
  v_max_u32 v38, v38, v115
L_CHK0:
  v_cmp_eq_u32 vcc, -1, v38
  s_cbranch_vccnz L_RETRY2_0
L_GO0:
  s_waitcnt lgkmcnt(0)
  v_mfma_f32_16x16x32_bf16 v[196:199], v[8:11], v[96:99], 0
  s_cmp_eq_u32 s52, 0
  s_cbranch_scc0 L_NG0
  s_add_u32 s33, s43, 0
  buffer_load_dwordx4 v[156:159], v2, s[8:11], s33 offen sc1
  s_add_u32 s33, s43, 17536
  buffer_load_dwordx4 v[160:163], v2, s[8:11], s33 offen sc1
  s_add_u32 s33, s43, 35072
  buffer_load_dwordx4 v[164:167], v2, s[8:11], s33 offen sc1
  s_add_u32 s33, s43, 52608
  buffer_load_dwordx4 v[168:171], v2, s[8:11], s33 offen sc1
  s_add_u32 s33, s43, 0
  buffer_load_dwordx2 v[172:173], v3, s[8:11], s33 offen offset:1024 sc1
  s_add_u32 s33, s43, 17536
  buffer_load_dwordx2 v[174:175], v3, s[8:11], s33 offen offset:1024 sc1
L_NG0:
  v_mfma_f32_16x16x32_bf16 v[200:203], v[12:15], v[96:99], 0
  v_mfma_f32_16x16x32_bf16 v[204:207], v[16:19], v[96:99], 0
  v_mfma_f32_16x16x32_bf16 v[248:251], v[20:23], v[96:99], 0
  v_mfma_f32_16x16x32_bf16 v[252:255], v[24:27], v[96:99], 0
  s_waitcnt lgkmcnt(0)
  v_mfma_f32_16x16x32_bf16 v[196:199], v[48:51], v[100:103], v[196:199]
  ds_read_b128 v[8:11], v2 offset:25600
  v_mfma_f32_16x16x32_bf16 v[200:203], v[52:55], v[100:103], v[200:203]
  ds_read_b128 v[12:15], v2 offset:26624
  v_mfma_f32_16x16x32_bf16 v[204:207], v[56:59], v[100:103], v[204:207]
  ds_read_b128 v[16:19], v2 offset:27648
  v_mfma_f32_16x16x32_bf16 v[248:251], v[60:63], v[100:103], v[248:251]
  ds_read_b128 v[20:23], v2 offset:28672
  v_mfma_f32_16x16x32_bf16 v[252:255], v[64:67], v[100:103], v[252:255]
  ds_read_b128 v[24:27], v2 offset:29696
  s_waitcnt lgkmcnt(5)
  v_mfma_f32_16x16x32_bf16 v[196:199], v[68:71], v[104:107], v[196:199]
  ds_read_b128 v[48:51], v2 offset:30720
  v_mfma_f32_16x16x32_bf16 v[200:203], v[72:75], v[104:107], v[200:203]
  ds_read_b128 v[52:55], v2 offset:31744
  v_mfma_f32_16x16x32_bf16 v[204:207], v[76:79], v[104:107], v[204:207]
  ds_read_b128 v[56:59], v2 offset:32768
  v_mfma_f32_16x16x32_bf16 v[248:251], v[80:83], v[104:107], v[248:251]
  ds_read_b128 v[60:63], v2 offset:33792
  v_mfma_f32_16x16x32_bf16 v[252:255], v[84:87], v[104:107], v[252:255]
  ds_read_b128 v[64:67], v2 offset:34816
  s_waitcnt lgkmcnt(5)
  v_mfma_f32_16x16x32_bf16 v[196:199], v[176:179], v[108:111], v[196:199]
  ds_read_b128 v[68:71], v2 offset:35840
  v_mfma_f32_16x16x32_bf16 v[200:203], v[180:183], v[108:111], v[200:203]
  ds_read_b128 v[72:75], v2 offset:36864
  v_mfma_f32_16x16x32_bf16 v[204:207], v[184:187], v[108:111], v[204:207]
  ds_read_b128 v[76:79], v2 offset:37888
  v_mfma_f32_16x16x32_bf16 v[248:251], v[188:191], v[108:111], v[248:251]
  ds_read_b128 v[80:83], v2 offset:38912
  v_mfma_f32_16x16x32_bf16 v[252:255], v[192:195], v[108:111], v[252:255]
  ds_read_b128 v[84:87], v2 offset:39936
  s_waitcnt lgkmcnt(5)
  v_mfma_f32_16x16x32_bf16 v[196:199], v[228:231], v[112:115], v[196:199]
  ds_read_b128 v[176:179], v2 offset:40960
  v_mfma_f32_16x16x32_bf16 v[200:203], v[232:235], v[112:115], v[200:203]
  ds_read_b128 v[180:183], v2 offset:41984
  v_mfma_f32_16x16x32_bf16 v[204:207], v[236:239], v[112:115], v[204:207]
  ds_read_b128 v[184:187], v2 offset:43008
  v_mfma_f32_16x16x32_bf16 v[248:251], v[240:243], v[112:115], v[248:251]
  ds_read_b128 v[188:191], v2 offset:44032
  v_mfma_f32_16x16x32_bf16 v[252:255], v[244:247], v[112:115], v[252:255]
  ds_read_b128 v[192:195], v2 offset:45056
  s_waitcnt vmcnt(12)
  s_bitcmp1_b32 s52, 1
  s_cbranch_scc1 L_PW1
L_PWR1:
  v_max3_u32 v38, v116, v117, v118
  v_max3_u32 v38, v38, v119, v120
  v_max3_u32 v38, v38, v121, v122
  v_max3_u32 v38, v38, v123, v124
  v_max3_u32 v38, v38, v125, v126
  v_max3_u32 v38, v38, v127, v128
  v_max3_u32 v38, v38, v129, v130
  v_max3_u32 v38, v38, v131, v132
  v_max3_u32 v38, v38, v133, v134
  v_max_u32 v38, v38, v135
L_CHK1:
  v_cmp_eq_u32 vcc, -1, v38
  s_cbranch_vccnz L_RETRY2_1
L_GO1:
  s_waitcnt lgkmcnt(5)
  v_mfma_f32_16x16x32_bf16 v[196:199], v[8:11], v[116:119], v[196:199]
  ds_read_b128 v[228:231], v2 offset:46080
  v_mfma_f32_16x16x32_bf16 v[200:203], v[12:15], v[116:119], v[200:203]
  ds_read_b128 v[232:235], v2 offset:47104
  v_mfma_f32_16x16x32_bf16 v[204:207], v[16:19], v[116:119], v[204:207]
  ds_read_b128 v[236:239], v2 offset:48128
  v_mfma_f32_16x16x32_bf16 v[248:251], v[20:23], v[116:119], v[248:251]
  ds_read_b128 v[240:243], v2 offset:49152
  v_mfma_f32_16x16x32_bf16 v[252:255], v[24:27], v[116:119], v[252:255]
  ds_read_b128 v[244:247], v2 offset:50176
  s_waitcnt lgkmcnt(5)
  v_mfma_f32_16x16x32_bf16 v[196:199], v[48:51], v[120:123], v[196:199]
  ds_read_b128 v[8:11], v4 offset:0
  v_mfma_f32_16x16x32_bf16 v[200:203], v[52:55], v[120:123], v[200:203]
  ds_read_b128 v[12:15], v4 offset:1024
  v_mfma_f32_16x16x32_bf16 v[204:207], v[56:59], v[120:123], v[204:207]
  ds_read_b128 v[16:19], v4 offset:2048
  v_mfma_f32_16x16x32_bf16 v[248:251], v[60:63], v[120:123], v[248:251]
  ds_read_b128 v[20:23], v4 offset:3072
  v_mfma_f32_16x16x32_bf16 v[252:255], v[64:67], v[120:123], v[252:255]
  ds_read_b128 v[24:27], v4 offset:4096
  s_waitcnt lgkmcnt(5)
  v_mfma_f32_16x16x32_bf16 v[196:199], v[68:71], v[124:127], v[196:199]
  ds_read_b128 v[48:51], v4 offset:5120
  v_mfma_f32_16x16x32_bf16 v[200:203], v[72:75], v[124:127], v[200:203]
  ds_read_b128 v[52:55], v4 offset:6144
  v_mfma_f32_16x16x32_bf16 v[204:207], v[76:79], v[124:127], v[204:207]
  ds_read_b128 v[56:59], v4 offset:7168
  v_mfma_f32_16x16x32_bf16 v[248:251], v[80:83], v[124:127], v[248:251]
  ds_read_b128 v[60:63], v4 offset:8192
  v_mfma_f32_16x16x32_bf16 v[252:255], v[84:87], v[124:127], v[252:255]
  ds_read_b128 v[64:67], v4 offset:9216
  s_waitcnt lgkmcnt(5)
  v_mfma_f32_16x16x32_bf16 v[196:199], v[176:179], v[128:131], v[196:199]
  ds_read_b128 v[68:71], v4 offset:10240
  v_mfma_f32_16x16x32_bf16 v[200:203], v[180:183], v[128:131], v[200:203]
  ds_read_b128 v[72:75], v4 offset:11264
  v_mfma_f32_16x16x32_bf16 v[204:207], v[184:187], v[128:131], v[204:207]
  ds_read_b128 v[76:79], v4 offset:12288
  v_mfma_f32_16x16x32_bf16 v[248:251], v[188:191], v[128:131], v[248:251]
  ds_read_b128 v[80:83], v4 offset:13312
  v_mfma_f32_16x16x32_bf16 v[252:255], v[192:195], v[128:131], v[252:255]
  ds_read_b128 v[84:87], v4 offset:14336
  s_waitcnt lgkmcnt(5)
  v_mfma_f32_16x16x32_bf16 v[196:199], v[228:231], v[132:135], v[196:199]
  ds_read_b128 v[176:179], v4 offset:15360
  v_mfma_f32_16x16x32_bf16 v[200:203], v[232:235], v[132:135], v[200:203]
  ds_read_b128 v[180:183], v4 offset:16384
  v_mfma_f32_16x16x32_bf16 v[204:207], v[236:239], v[132:135], v[204:207]
  ds_read_b128 v[184:187], v4 offset:17408
  v_mfma_f32_16x16x32_bf16 v[248:251], v[240:243], v[132:135], v[248:251]
  ds_read_b128 v[188:191], v4 offset:18432
  v_mfma_f32_16x16x32_bf16 v[252:255], v[244:247], v[132:135], v[252:255]
  ds_read_b128 v[192:195], v4 offset:19456
  s_waitcnt vmcnt(6)
  s_bitcmp1_b32 s52, 2
  s_cbranch_scc1 L_PW2
L_PWR2:
  v_max3_u32 v38, v136, v137, v138
  v_max3_u32 v38, v38, v139, v140
  v_max3_u32 v38, v38, v141, v142
  v_max3_u32 v38, v38, v143, v144
  v_max3_u32 v38, v38, v145, v146
  v_max3_u32 v38, v38, v147, v148
  v_max3_u32 v38, v38, v149, v150
  v_max3_u32 v38, v38, v151, v152
  v_max3_u32 v38, v38, v153, v154
  v_max_u32 v38, v38, v155
L_CHK2:
  v_cmp_eq_u32 vcc, -1, v38
  s_cbranch_vccnz L_RETRY2_2
L_GO2:
  s_waitcnt lgkmcnt(5)
  v_mfma_f32_16x16x32_bf16 v[196:199], v[8:11], v[136:139], v[196:199]
  ds_read_b128 v[228:231], v4 offset:20480
  v_mfma_f32_16x16x32_bf16 v[200:203], v[12:15], v[136:139], v[200:203]
  ds_read_b128 v[232:235], v4 offset:21504
  v_mfma_f32_16x16x32_bf16 v[204:207], v[16:19], v[136:139], v[204:207]
  ds_read_b128 v[236:239], v4 offset:22528
  v_mfma_f32_16x16x32_bf16 v[248:251], v[20:23], v[136:139], v[248:251]
  ds_read_b128 v[240:243], v4 offset:23552
  v_mfma_f32_16x16x32_bf16 v[252:255], v[24:27], v[136:139], v[252:255]
  ds_read_b128 v[244:247], v4 offset:24576
  s_waitcnt lgkmcnt(5)
  v_mfma_f32_16x16x32_bf16 v[196:199], v[48:51], v[140:143], v[196:199]
  ds_read_b128 v[8:11], v4 offset:25600
  v_mfma_f32_16x16x32_bf16 v[200:203], v[52:55], v[140:143], v[200:203]
  ds_read_b128 v[12:15], v4 offset:26624
  v_mfma_f32_16x16x32_bf16 v[204:207], v[56:59], v[140:143], v[204:207]
  ds_read_b128 v[16:19], v4 offset:27648
  v_mfma_f32_16x16x32_bf16 v[248:251], v[60:63], v[140:143], v[248:251]
  ds_read_b128 v[20:23], v4 offset:28672
  v_mfma_f32_16x16x32_bf16 v[252:255], v[64:67], v[140:143], v[252:255]
  ds_read_b128 v[24:27], v4 offset:29696
  s_waitcnt lgkmcnt(5)
  v_mfma_f32_16x16x32_bf16 v[196:199], v[68:71], v[144:147], v[196:199]
  ds_read_b128 v[48:51], v4 offset:30720
  v_mfma_f32_16x16x32_bf16 v[200:203], v[72:75], v[144:147], v[200:203]
  ds_read_b128 v[52:55], v4 offset:31744
  v_mfma_f32_16x16x32_bf16 v[204:207], v[76:79], v[144:147], v[204:207]
  ds_read_b128 v[56:59], v4 offset:32768
  v_mfma_f32_16x16x32_bf16 v[248:251], v[80:83], v[144:147], v[248:251]
  ds_read_b128 v[60:63], v4 offset:33792
  v_mfma_f32_16x16x32_bf16 v[252:255], v[84:87], v[144:147], v[252:255]
  ds_read_b128 v[64:67], v4 offset:34816
  s_waitcnt lgkmcnt(5)
  v_mfma_f32_16x16x32_bf16 v[196:199], v[176:179], v[148:151], v[196:199]
  ds_read_b128 v[68:71], v4 offset:35840
  v_mfma_f32_16x16x32_bf16 v[200:203], v[180:183], v[148:151], v[200:203]
  ds_read_b128 v[72:75], v4 offset:36864
  v_mfma_f32_16x16x32_bf16 v[204:207], v[184:187], v[148:151], v[204:207]
  ds_read_b128 v[76:79], v4 offset:37888
  v_mfma_f32_16x16x32_bf16 v[248:251], v[188:191], v[148:151], v[248:251]
  ds_read_b128 v[80:83], v4 offset:38912
  v_mfma_f32_16x16x32_bf16 v[252:255], v[192:195], v[148:151], v[252:255]
  ds_read_b128 v[84:87], v4 offset:39936
  s_waitcnt lgkmcnt(5)
  v_mfma_f32_16x16x32_bf16 v[196:199], v[228:231], v[152:155], v[196:199]
  ds_read_b128 v[176:179], v4 offset:40960
  v_mfma_f32_16x16x32_bf16 v[200:203], v[232:235], v[152:155], v[200:203]
  ds_read_b128 v[180:183], v4 offset:41984
  v_mfma_f32_16x16x32_bf16 v[204:207], v[236:239], v[152:155], v[204:207]
  ds_read_b128 v[184:187], v4 offset:43008
  v_mfma_f32_16x16x32_bf16 v[248:251], v[240:243], v[152:155], v[248:251]
  ds_read_b128 v[188:191], v4 offset:44032
  v_mfma_f32_16x16x32_bf16 v[252:255], v[244:247], v[152:155], v[252:255]
  ds_read_b128 v[192:195], v4 offset:45056
  s_waitcnt vmcnt(0)
  v_max3_u32 v38, v156, v157, v158
  v_max3_u32 v38, v38, v159, v160
  v_max3_u32 v38, v38, v161, v162
  v_max3_u32 v38, v38, v163, v164
  v_max3_u32 v38, v38, v165, v166
  v_max3_u32 v38, v38, v167, v168
  v_max3_u32 v38, v38, v169, v170
  v_max3_u32 v38, v38, v171, v172
  v_max3_u32 v38, v38, v173, v174
  v_max_u32 v38, v38, v175
L_CHK3:
  v_cmp_eq_u32 vcc, -1, v38
  s_cbranch_vccnz L_RETRY2_3
L_GO3:
  s_waitcnt lgkmcnt(5)
  v_mfma_f32_16x16x32_bf16 v[196:199], v[8:11], v[156:159], v[196:199]
  ds_read_b128 v[228:231], v4 offset:46080
  v_mfma_f32_16x16x32_bf16 v[200:203], v[12:15], v[156:159], v[200:203]
  ds_read_b128 v[232:235], v4 offset:47104
  v_mfma_f32_16x16x32_bf16 v[204:207], v[16:19], v[156:159], v[204:207]
  ds_read_b128 v[236:239], v4 offset:48128
  v_mfma_f32_16x16x32_bf16 v[248:251], v[20:23], v[156:159], v[248:251]
  ds_read_b128 v[240:243], v4 offset:49152
  v_mfma_f32_16x16x32_bf16 v[252:255], v[24:27], v[156:159], v[252:255]
  ds_read_b128 v[244:247], v4 offset:50176
  s_waitcnt lgkmcnt(5)
  v_mfma_f32_16x16x32_bf16 v[196:199], v[48:51], v[160:163], v[196:199]
  v_mfma_f32_16x16x32_bf16 v[200:203], v[52:55], v[160:163], v[200:203]
  v_mfma_f32_16x16x32_bf16 v[204:207], v[56:59], v[160:163], v[204:207]
  v_mfma_f32_16x16x32_bf16 v[248:251], v[60:63], v[160:163], v[248:251]
  v_mfma_f32_16x16x32_bf16 v[252:255], v[64:67], v[160:163], v[252:255]
  s_waitcnt lgkmcnt(0)
  v_mfma_f32_16x16x32_bf16 v[196:199], v[68:71], v[164:167], v[196:199]
  v_mfma_f32_16x16x32_bf16 v[200:203], v[72:75], v[164:167], v[200:203]
  v_mfma_f32_16x16x32_bf16 v[204:207], v[76:79], v[164:167], v[204:207]
  v_mfma_f32_16x16x32_bf16 v[248:251], v[80:83], v[164:167], v[248:251]
  v_mfma_f32_16x16x32_bf16 v[252:255], v[84:87], v[164:167], v[252:255]
  s_waitcnt lgkmcnt(0)
  ds_read_b96 v[44:46], v32 offset:16
  v_mfma_f32_16x16x32_bf16 v[196:199], v[176:179], v[168:171], v[196:199]
  v_mfma_f32_16x16x32_bf16 v[200:203], v[180:183], v[168:171], v[200:203]
  v_mfma_f32_16x16x32_bf16 v[204:207], v[184:187], v[168:171], v[204:207]
  v_mfma_f32_16x16x32_bf16 v[248:251], v[188:191], v[168:171], v[248:251]
  v_mfma_f32_16x16x32_bf16 v[252:255], v[192:195], v[168:171], v[252:255]
  s_waitcnt lgkmcnt(0)
  v_mfma_f32_16x16x32_bf16 v[196:199], v[228:231], v[172:175], v[196:199]
  v_mfma_f32_16x16x32_bf16 v[200:203], v[232:235], v[172:175], v[200:203]
  v_mfma_f32_16x16x32_bf16 v[204:207], v[236:239], v[172:175], v[204:207]
  v_mfma_f32_16x16x32_bf16 v[248:251], v[240:243], v[172:175], v[248:251]
  v_mfma_f32_16x16x32_bf16 v[252:255], v[244:247], v[172:175], v[252:255]
L_FDC:
  v_readfirstlane_b32 s34, v44
  v_readfirstlane_b32 s32, v45
  v_readfirstlane_b32 s33, v46
  s_cmp_eq_u32 s34, 0
  s_cbranch_scc1 L_FDW
L_FDX:
  s_lshr_b32 s30, s32, 4
  s_lshr_b32 s31, s33, 4
  s_cmp_eq_u32 s30, s3
  s_cbranch_scc1 L_UPD0
L_UPD0R:
  s_cmp_eq_u32 s31, s3
  s_cbranch_scc1 L_UPD1
L_UPD1R:
  v_pk_fma_f32 v[196:197], v[196:197], v[28:29], v[208:209]
  v_pk_fma_f32 v[198:199], v[198:199], v[28:29], v[210:211]
  v_cvt_pk_bf16_f32 v68, v196, v197
  v_cvt_pk_bf16_f32 v69, v198, v199
  ds_write_b64 v31, v[68:69] offset:0
  v_pk_fma_f32 v[200:201], v[200:201], v[28:29], v[212:213]
  v_pk_fma_f32 v[202:203], v[202:203], v[28:29], v[214:215]
  v_cvt_pk_bf16_f32 v70, v200, v201
  v_cvt_pk_bf16_f32 v71, v202, v203
  ds_write_b64 v31, v[70:71] offset:8
  v_pk_fma_f32 v[204:205], v[204:205], v[28:29], v[216:217]
  v_pk_fma_f32 v[206:207], v[206:207], v[28:29], v[218:219]
  v_cvt_pk_bf16_f32 v72, v204, v205
  v_cvt_pk_bf16_f32 v73, v206, v207
  ds_write_b64 v31, v[72:73] offset:16
  v_pk_fma_f32 v[248:249], v[248:249], v[28:29], v[220:221]
  v_pk_fma_f32 v[250:251], v[250:251], v[28:29], v[222:223]
  v_cvt_pk_bf16_f32 v74, v248, v249
  v_cvt_pk_bf16_f32 v75, v250, v251
  ds_write_b64 v31, v[74:75] offset:24
  v_pk_fma_f32 v[252:253], v[252:253], v[28:29], v[224:225]
  v_pk_fma_f32 v[254:255], v[254:255], v[28:29], v[226:227]
  v_cvt_pk_bf16_f32 v76, v252, v253
  v_cvt_pk_bf16_f32 v77, v254, v255
  ds_write_b64 v31, v[76:77] offset:32
  ds_read_b128 v[48:51], v93 offset:0
  ds_read_b128 v[52:55], v93 offset:1024
  ds_read_b128 v[56:59], v93 offset:2048
  s_waitcnt lgkmcnt(2)
  buffer_store_dwordx4 v[48:51], v90, s[16:19], s45 offen
  s_waitcnt lgkmcnt(1)
  buffer_store_dwordx4 v[52:55], v91, s[16:19], s45 offen
  s_waitcnt lgkmcnt(0)
  s_mov_b32 exec_hi, 0
  buffer_store_dwordx4 v[56:59], v92, s[16:19], s45 offen
  s_or_b32 s30, s2, s3
  s_cbranch_scc1 L_NONON
  v_mov_b32 v8, 0
  s_mov_b64 exec, 1
  buffer_store_dword v1, v8, s[8:11], 0 offen
L_NONON:
  s_mov_b64 exec, -1
  s_endpgm
L_G2W:
  s_mov_b32 s51, 0
L_G2P:
  ds_read_b32 v38, v32 offset:12
  s_waitcnt lgkmcnt(0)
  v_readfirstlane_b32 s49, v38
  s_nop 0
  s_cmp_eq_u32 s49, s51
  s_cbranch_scc1 L_G2P
  s_andn2_b32 s49, s49, s51
  s_cmp_lg_u32 s49, 15
  s_cbranch_scc1 L_G2Q
  s_add_u32 s33, s40, 0
  buffer_load_dwordx4 v[96:99], v2, s[8:11], s33 offen sc1
  s_add_u32 s33, s40, 17536
  buffer_load_dwordx4 v[100:103], v2, s[8:11], s33 offen sc1
  s_add_u32 s33, s40, 35072
  buffer_load_dwordx4 v[104:107], v2, s[8:11], s33 offen sc1
  s_add_u32 s33, s40, 52608
  buffer_load_dwordx4 v[108:111], v2, s[8:11], s33 offen sc1
  s_add_u32 s33, s40, 0
  buffer_load_dwordx2 v[112:113], v3, s[8:11], s33 offen offset:1024 sc1
  s_add_u32 s33, s40, 17536
  buffer_load_dwordx2 v[114:115], v3, s[8:11], s33 offen offset:1024 sc1
  s_add_u32 s33, s41, 0
  buffer_load_dwordx4 v[116:119], v2, s[8:11], s33 offen sc1
  s_add_u32 s33, s41, 17536
  buffer_load_dwordx4 v[120:123], v2, s[8:11], s33 offen sc1
  s_add_u32 s33, s41, 35072
  buffer_load_dwordx4 v[124:127], v2, s[8:11], s33 offen sc1
  s_add_u32 s33, s41, 52608
  buffer_load_dwordx4 v[128:131], v2, s[8:11], s33 offen sc1
  s_add_u32 s33, s41, 0
  buffer_load_dwordx2 v[132:133], v3, s[8:11], s33 offen offset:1024 sc1
  s_add_u32 s33, s41, 17536
  buffer_load_dwordx2 v[134:135], v3, s[8:11], s33 offen offset:1024 sc1
  s_branch L_G2D
L_G2Q:
  s_or_b32 s51, s51, s49
  s_bitcmp0_b32 s49, 0
  s_cbranch_scc1 G228
  s_add_u32 s33, s40, 0
  buffer_load_dwordx4 v[96:99], v2, s[8:11], s33 offen sc1
  s_add_u32 s33, s40, 17536
  buffer_load_dwordx4 v[100:103], v2, s[8:11], s33 offen sc1
  s_add_u32 s33, s40, 35072
  buffer_load_dwordx4 v[104:107], v2, s[8:11], s33 offen sc1
  s_add_u32 s33, s40, 52608
  buffer_load_dwordx4 v[108:111], v2, s[8:11], s33 offen sc1
  s_add_u32 s33, s40, 0
  buffer_load_dwordx2 v[112:113], v3, s[8:11], s33 offen offset:1024 sc1
  s_add_u32 s33, s40, 17536
  buffer_load_dwordx2 v[114:115], v3, s[8:11], s33 offen offset:1024 sc1
G228:
  s_bitcmp0_b32 s49, 1
  s_cbranch_scc1 G229
  s_add_u32 s33, s41, 0
  buffer_load_dwordx4 v[116:119], v2, s[8:11], s33 offen sc1
  s_add_u32 s33, s41, 17536
  buffer_load_dwordx4 v[120:123], v2, s[8:11], s33 offen sc1
  s_add_u32 s33, s41, 35072
  buffer_load_dwordx4 v[124:127], v2, s[8:11], s33 offen sc1
  s_add_u32 s33, s41, 52608
  buffer_load_dwordx4 v[128:131], v2, s[8:11], s33 offen sc1
  s_add_u32 s33, s41, 0
  buffer_load_dwordx2 v[132:133], v3, s[8:11], s33 offen offset:1024 sc1
  s_add_u32 s33, s41, 17536
  buffer_load_dwordx2 v[134:135], v3, s[8:11], s33 offen offset:1024 sc1
G229:
  s_bitcmp0_b32 s49, 2
  s_cbranch_scc1 G230
  s_add_u32 s33, s42, 0
  buffer_load_dwordx4 v[136:139], v2, s[8:11], s33 offen sc1
  s_add_u32 s33, s42, 17536
  buffer_load_dwordx4 v[140:143], v2, s[8:11], s33 offen sc1
  s_add_u32 s33, s42, 35072
  buffer_load_dwordx4 v[144:147], v2, s[8:11], s33 offen sc1
  s_add_u32 s33, s42, 52608
  buffer_load_dwordx4 v[148:151], v2, s[8:11], s33 offen sc1
  s_add_u32 s33, s42, 0
  buffer_load_dwordx2 v[152:153], v3, s[8:11], s33 offen offset:1024 sc1
  s_add_u32 s33, s42, 17536
  buffer_load_dwordx2 v[154:155], v3, s[8:11], s33 offen offset:1024 sc1
G230:
  s_bitcmp0_b32 s49, 3
  s_cbranch_scc1 G231
  s_add_u32 s33, s43, 0
  buffer_load_dwordx4 v[156:159], v2, s[8:11], s33 offen sc1
  s_add_u32 s33, s43, 17536
  buffer_load_dwordx4 v[160:163], v2, s[8:11], s33 offen sc1
  s_add_u32 s33, s43, 35072
  buffer_load_dwordx4 v[164:167], v2, s[8:11], s33 offen sc1
  s_add_u32 s33, s43, 52608
  buffer_load_dwordx4 v[168:171], v2, s[8:11], s33 offen sc1
  s_add_u32 s33, s43, 0
  buffer_load_dwordx2 v[172:173], v3, s[8:11], s33 offen offset:1024 sc1
  s_add_u32 s33, s43, 17536
  buffer_load_dwordx2 v[174:175], v3, s[8:11], s33 offen offset:1024 sc1
G231:
  s_cmp_lg_u32 s51, 15
  s_cbranch_scc1 L_G2P
  s_mov_b32 s52, s49
  s_bcnt1_i32_b32 s34, s49
  s_waitcnt vmcnt(18)
  s_cmp_eq_u32 s34, 3
  s_cbranch_scc1 L_G2X
  s_waitcnt vmcnt(12)
  s_cmp_eq_u32 s34, 2
  s_cbranch_scc1 L_G2X
  s_waitcnt vmcnt(6)
  s_branch L_G2X
L_FDW:
  ds_read_b96 v[44:46], v32 offset:16
  s_sub_u32 s35, s35, 1
  s_cmp_lt_i32 s35, 0
  s_cbranch_scc1 L_FDX
  s_waitcnt lgkmcnt(0)
  s_branch L_FDC
L_UPD0:
  s_and_b32 s34, s32, 15
  v_and_b32 v8, 15, v0
  v_lshrrev_b32 v9, 4, v0
  v_mul_u32_u24 v9, 80, v9
  v_add_u32 v9, 145920, v9
  v_cmp_eq_u32 vcc, s34, v8
  ds_read_b128 v[48:51], v9 offset:0
  ds_read_b128 v[52:55], v9 offset:16
  ds_read_b128 v[56:59], v9 offset:32
  ds_read_b128 v[60:63], v9 offset:48
  ds_read_b128 v[64:67], v9 offset:64
  s_waitcnt lgkmcnt(0)
  s_mov_b64 exec, vcc
  v_fmac_f32 v208, v48, v42
  v_fmac_f32 v209, v49, v42
  v_fmac_f32 v210, v50, v42
  v_fmac_f32 v211, v51, v42
  v_fmac_f32 v212, v52, v42
  v_fmac_f32 v213, v53, v42
  v_fmac_f32 v214, v54, v42
  v_fmac_f32 v215, v55, v42
  v_fmac_f32 v216, v56, v42
  v_fmac_f32 v217, v57, v42
  v_fmac_f32 v218, v58, v42
  v_fmac_f32 v219, v59, v42
  v_fmac_f32 v220, v60, v42
  v_fmac_f32 v221, v61, v42
  v_fmac_f32 v222, v62, v42
  v_fmac_f32 v223, v63, v42
  v_fmac_f32 v224, v64, v42
  v_fmac_f32 v225, v65, v42
  v_fmac_f32 v226, v66, v42
  v_fmac_f32 v227, v67, v42
  s_mov_b64 exec, -1
  s_branch L_UPD0R
L_UPD1:
  s_and_b32 s34, s33, 15
  v_and_b32 v8, 15, v0
  v_lshrrev_b32 v9, 4, v0
  v_mul_u32_u24 v9, 80, v9
  v_add_u32 v9, 146240, v9
  v_cmp_eq_u32 vcc, s34, v8
  ds_read_b128 v[48:51], v9 offset:0
  ds_read_b128 v[52:55], v9 offset:16
  ds_read_b128 v[56:59], v9 offset:32
  ds_read_b128 v[60:63], v9 offset:48
  ds_read_b128 v[64:67], v9 offset:64
  s_waitcnt lgkmcnt(0)
  s_mov_b64 exec, vcc
  v_fmac_f32 v208, v48, v42
  v_fmac_f32 v209, v49, v42
  v_fmac_f32 v210, v50, v42
  v_fmac_f32 v211, v51, v42
  v_fmac_f32 v212, v52, v42
  v_fmac_f32 v213, v53, v42
  v_fmac_f32 v214, v54, v42
  v_fmac_f32 v215, v55, v42
  v_fmac_f32 v216, v56, v42
  v_fmac_f32 v217, v57, v42
  v_fmac_f32 v218, v58, v42
  v_fmac_f32 v219, v59, v42
  v_fmac_f32 v220, v60, v42
  v_fmac_f32 v221, v61, v42
  v_fmac_f32 v222, v62, v42
  v_fmac_f32 v223, v63, v42
  v_fmac_f32 v224, v64, v42
  v_fmac_f32 v225, v65, v42
  v_fmac_f32 v226, v66, v42
  v_fmac_f32 v227, v67, v42
  s_mov_b64 exec, -1
  s_branch L_UPD1R
L_RETRY1:
  s_mov_b32 s25, 0
  v_max3_u32 v38, v112, v113, v114
  v_max3_u32 v38, v38, v115, v116
  v_max3_u32 v38, v38, v117, v118
  v_max3_u32 v38, v38, v119, v120
  v_max3_u32 v38, v38, v121, v122
  v_max3_u32 v38, v38, v123, v124
  v_max3_u32 v38, v38, v125, v126
  v_max_u32 v38, v38, v127
  v_cmp_eq_u32 vcc, -1, v38
  s_cbranch_vccz L_R1N0
  s_mov_b32 s25, 1
  buffer_load_dwordx4 v[112:115], v34, s[8:11], s20 offen offset:0 sc1
  buffer_load_dwordx4 v[116:119], v34, s[8:11], s20 offen offset:1024 sc1
  buffer_load_dwordx4 v[120:123], v34, s[8:11], s20 offen offset:2048 sc1
  buffer_load_dwordx4 v[124:127], v35, s[8:11], s20 offen sc1
L_R1N0:
  v_max3_u32 v38, v128, v129, v130
  v_max3_u32 v38, v38, v131, v132
  v_max3_u32 v38, v38, v133, v134
  v_max3_u32 v38, v38, v135, v136
  v_max3_u32 v38, v38, v137, v138
  v_max3_u32 v38, v38, v139, v140
  v_max3_u32 v38, v38, v141, v142
  v_max_u32 v38, v38, v143
  v_cmp_eq_u32 vcc, -1, v38
  s_cbranch_vccz L_R1N1
  s_mov_b32 s25, 1
  buffer_load_dwordx4 v[128:131], v34, s[8:11], s21 offen offset:0 sc1
  buffer_load_dwordx4 v[132:135], v34, s[8:11], s21 offen offset:1024 sc1
  buffer_load_dwordx4 v[136:139], v34, s[8:11], s21 offen offset:2048 sc1
  buffer_load_dwordx4 v[140:143], v35, s[8:11], s21 offen sc1
L_R1N1:
  v_max3_u32 v38, v144, v145, v146
  v_max3_u32 v38, v38, v147, v148
  v_max3_u32 v38, v38, v149, v150
  v_max3_u32 v38, v38, v151, v152
  v_max3_u32 v38, v38, v153, v154
  v_max3_u32 v38, v38, v155, v156
  v_max3_u32 v38, v38, v157, v158
  v_max_u32 v38, v38, v159
  v_cmp_eq_u32 vcc, -1, v38
  s_cbranch_vccz L_R1N2
  s_mov_b32 s25, 1
  buffer_load_dwordx4 v[144:147], v34, s[8:11], s22 offen offset:0 sc1
  buffer_load_dwordx4 v[148:151], v34, s[8:11], s22 offen offset:1024 sc1
  buffer_load_dwordx4 v[152:155], v34, s[8:11], s22 offen offset:2048 sc1
  buffer_load_dwordx4 v[156:159], v35, s[8:11], s22 offen sc1
L_R1N2:
  v_max3_u32 v38, v160, v161, v162
  v_max3_u32 v38, v38, v163, v164
  v_max3_u32 v38, v38, v165, v166
  v_max3_u32 v38, v38, v167, v168
  v_max3_u32 v38, v38, v169, v170
  v_max3_u32 v38, v38, v171, v172
  v_max3_u32 v38, v38, v173, v174
  v_max_u32 v38, v38, v175
  v_cmp_eq_u32 vcc, -1, v38
  s_cbranch_vccz L_R1N3
  s_mov_b32 s25, 1
  buffer_load_dwordx4 v[160:163], v34, s[8:11], s23 offen offset:0 sc1
  buffer_load_dwordx4 v[164:167], v34, s[8:11], s23 offen offset:1024 sc1
  buffer_load_dwordx4 v[168:171], v34, s[8:11], s23 offen offset:2048 sc1
  buffer_load_dwordx4 v[172:175], v35, s[8:11], s23 offen sc1
L_R1N3:
  s_cmp_eq_u32 s25, 0
  s_cbranch_scc1 L_RED_OK
  s_waitcnt vmcnt(0)
  s_sub_u32 s35, s35, 50
  s_cmp_lt_i32 s35, 0
  s_cbranch_scc1 L_RED_OK
  s_branch L_RED
L_RETRY2_0:
  s_sub_u32 s35, s35, 50
  s_cmp_lt_i32 s35, 0
  s_cbranch_scc1 L_GO0
  s_add_u32 s33, s40, 0
  buffer_load_dwordx4 v[96:99], v2, s[8:11], s33 offen sc1
  s_add_u32 s33, s40, 17536
  buffer_load_dwordx4 v[100:103], v2, s[8:11], s33 offen sc1
  s_add_u32 s33, s40, 35072
  buffer_load_dwordx4 v[104:107], v2, s[8:11], s33 offen sc1
  s_add_u32 s33, s40, 52608
  buffer_load_dwordx4 v[108:111], v2, s[8:11], s33 offen sc1
  s_add_u32 s33, s40, 0
  buffer_load_dwordx2 v[112:113], v3, s[8:11], s33 offen offset:1024 sc1
  s_add_u32 s33, s40, 17536
  buffer_load_dwordx2 v[114:115], v3, s[8:11], s33 offen offset:1024 sc1
  s_waitcnt vmcnt(0)
  v_max3_u32 v38, v96, v97, v98
  v_max3_u32 v38, v38, v99, v100
  v_max3_u32 v38, v38, v101, v102
  v_max3_u32 v38, v38, v103, v104
  v_max3_u32 v38, v38, v105, v106
  v_max3_u32 v38, v38, v107, v108
  v_max3_u32 v38, v38, v109, v110
  v_max3_u32 v38, v38, v111, v112
  v_max3_u32 v38, v38, v113, v114
  v_max_u32 v38, v38, v115
  s_branch L_CHK0
L_PW0:
  s_waitcnt vmcnt(0)
  s_and_b32 s52, s52, 8
  s_or_b32 s52, s52, 16
  s_branch L_PWR0
L_RETRY2_1:
  s_sub_u32 s35, s35, 50
  s_cmp_lt_i32 s35, 0
  s_cbranch_scc1 L_GO1
  s_add_u32 s33, s41, 0
  buffer_load_dwordx4 v[116:119], v2, s[8:11], s33 offen sc1
  s_add_u32 s33, s41, 17536
  buffer_load_dwordx4 v[120:123], v2, s[8:11], s33 offen sc1
  s_add_u32 s33, s41, 35072
  buffer_load_dwordx4 v[124:127], v2, s[8:11], s33 offen sc1
  s_add_u32 s33, s41, 52608
  buffer_load_dwordx4 v[128:131], v2, s[8:11], s33 offen sc1
  s_add_u32 s33, s41, 0
  buffer_load_dwordx2 v[132:133], v3, s[8:11], s33 offen offset:1024 sc1
  s_add_u32 s33, s41, 17536
  buffer_load_dwordx2 v[134:135], v3, s[8:11], s33 offen offset:1024 sc1
  s_waitcnt vmcnt(0)
  v_max3_u32 v38, v116, v117, v118
  v_max3_u32 v38, v38, v119, v120
  v_max3_u32 v38, v38, v121, v122
  v_max3_u32 v38, v38, v123, v124
  v_max3_u32 v38, v38, v125, v126
  v_max3_u32 v38, v38, v127, v128
  v_max3_u32 v38, v38, v129, v130
  v_max3_u32 v38, v38, v131, v132
  v_max3_u32 v38, v38, v133, v134
  v_max_u32 v38, v38, v135
  s_branch L_CHK1
L_PW1:
  s_waitcnt vmcnt(0)
  s_and_b32 s52, s52, 8
  s_or_b32 s52, s52, 16
  s_branch L_PWR1
L_RETRY2_2:
  s_sub_u32 s35, s35, 50
  s_cmp_lt_i32 s35, 0
  s_cbranch_scc1 L_GO2
  s_add_u32 s33, s42, 0
  buffer_load_dwordx4 v[136:139], v2, s[8:11], s33 offen sc1
  s_add_u32 s33, s42, 17536
  buffer_load_dwordx4 v[140:143], v2, s[8:11], s33 offen sc1
  s_add_u32 s33, s42, 35072
  buffer_load_dwordx4 v[144:147], v2, s[8:11], s33 offen sc1
  s_add_u32 s33, s42, 52608
  buffer_load_dwordx4 v[148:151], v2, s[8:11], s33 offen sc1
  s_add_u32 s33, s42, 0
  buffer_load_dwordx2 v[152:153], v3, s[8:11], s33 offen offset:1024 sc1
  s_add_u32 s33, s42, 17536
  buffer_load_dwordx2 v[154:155], v3, s[8:11], s33 offen offset:1024 sc1
  s_waitcnt vmcnt(0)
  v_max3_u32 v38, v136, v137, v138
  v_max3_u32 v38, v38, v139, v140
  v_max3_u32 v38, v38, v141, v142
  v_max3_u32 v38, v38, v143, v144
  v_max3_u32 v38, v38, v145, v146
  v_max3_u32 v38, v38, v147, v148
  v_max3_u32 v38, v38, v149, v150
  v_max3_u32 v38, v38, v151, v152
  v_max3_u32 v38, v38, v153, v154
  v_max_u32 v38, v38, v155
  s_branch L_CHK2
L_PW2:
  s_waitcnt vmcnt(0)
  s_and_b32 s52, s52, 8
  s_or_b32 s52, s52, 16
  s_branch L_PWR2
L_RETRY2_3:
  s_sub_u32 s35, s35, 50
  s_cmp_lt_i32 s35, 0
  s_cbranch_scc1 L_GO3
  s_add_u32 s33, s43, 0
  buffer_load_dwordx4 v[156:159], v2, s[8:11], s33 offen sc1
  s_add_u32 s33, s43, 17536
  buffer_load_dwordx4 v[160:163], v2, s[8:11], s33 offen sc1
  s_add_u32 s33, s43, 35072
  buffer_load_dwordx4 v[164:167], v2, s[8:11], s33 offen sc1
  s_add_u32 s33, s43, 52608
  buffer_load_dwordx4 v[168:171], v2, s[8:11], s33 offen sc1
  s_add_u32 s33, s43, 0
  buffer_load_dwordx2 v[172:173], v3, s[8:11], s33 offen offset:1024 sc1
  s_add_u32 s33, s43, 17536
  buffer_load_dwordx2 v[174:175], v3, s[8:11], s33 offen offset:1024 sc1
  s_waitcnt vmcnt(0)
  v_max3_u32 v38, v156, v157, v158
  v_max3_u32 v38, v38, v159, v160
  v_max3_u32 v38, v38, v161, v162
  v_max3_u32 v38, v38, v163, v164
  v_max3_u32 v38, v38, v165, v166
  v_max3_u32 v38, v38, v167, v168
  v_max3_u32 v38, v38, v169, v170
  v_max3_u32 v38, v38, v171, v172
  v_max3_u32 v38, v38, v173, v174
  v_max_u32 v38, v38, v175
  s_branch L_CHK3
L_HELP:
  s_waitcnt lgkmcnt(0)
  s_load_dword s62, s[60:61], 0
  v_and_b32 v9, 3, v0
  v_lshl_add_u32 v9, v9, 2, 15
  v_bfe_u32 v10, v0, 3, 1
  v_lshl_add_u32 v9, v10, 1, v9
  v_and_b32 v9, 15, v9
  v_lshlrev_b32 v9, 4, v9
  v_lshl_add_u32 v9, v0, 8, v9
  v_add_u32 v9, 16384, v9
  v_add_u32 v10, 0x10000, v9
  v_lshlrev_b32 v2, 4, v0
  v_mov_b32 v4, 0
  v_mov_b32 v5, 0
  v_mov_b32 v6, 0
  v_mov_b32 v7, 0
  v_add_u32 v8, 137216, v2
  ds_write_b128 v8, v[4:7]
  ds_write_b128 v8, v[4:7] offset:1024
  v_mov_b32 v8, 144384
  ds_write_b128 v8, v[4:7]
  ds_write_b128 v8, v[4:7] offset:16
  ds_write_b128 v8, v[4:7] offset:32
  v_mov_b32 v12, -1
  v_mov_b32 v13, -1
  v_mov_b32 v14, -1
  v_mov_b32 v15, -1
  s_mov_b32 s8, s60
  s_mov_b32 s9, s61
  s_mov_b32 s10, 7114752
  s_mov_b32 s11, 0x20000
  s_mov_b32 s12, s54
  s_mov_b32 s13, s55
  s_mov_b32 s14, 1280
  s_mov_b32 s15, 0x20000
  s_mov_b32 s16, s46
  s_mov_b32 s17, s47
  s_mov_b32 s18, 1280
  s_mov_b32 s19, 0x20000
  v_lshlrev_b32 v3, 1, v0
  buffer_load_ushort v32, v3, s[12:15], 0 offen offset:0
  buffer_load_ushort v48, v3, s[16:19], 0 offen offset:0
  buffer_load_ushort v33, v3, s[12:15], 0 offen offset:128
  buffer_load_ushort v49, v3, s[16:19], 0 offen offset:128
  s_mov_b32 s96, 1
  s_getpc_b64 s[24:25]
L_PC2:
  s_add_u32 s24, s24, L_CLR-L_PC2
  s_addc_u32 s25, s25, 0
  s_waitcnt lgkmcnt(0)
  s_barrier
  s_and_b32 s31, s4, 3
  s_mul_i32 s34, s5, 17536
  s_add_u32 s34, s34, 20864
  s_lshl_b32 s33, s31, 2
  s_add_u32 s36, s33, 0
  s_and_b32 s36, s36, 15
  s_cmp_eq_u32 s36, s4
  s_cselect_b32 s32, 512, 0
  s_mul_i32 s36, s36, 280576
  s_add_u32 s36, s36, s34
  s_add_u32 s36, s36, s32
  s_add_u32 s37, s33, 1
  s_and_b32 s37, s37, 15
  s_cmp_eq_u32 s37, s4
  s_cselect_b32 s32, 512, 0
  s_mul_i32 s37, s37, 280576
  s_add_u32 s37, s37, s34
  s_add_u32 s37, s37, s32
  s_add_u32 s38, s33, 2
  s_and_b32 s38, s38, 15
  s_cmp_eq_u32 s38, s4
  s_cselect_b32 s32, 512, 0
  s_mul_i32 s38, s38, 280576
  s_add_u32 s38, s38, s34
  s_add_u32 s38, s38, s32
  s_add_u32 s39, s33, 3
  s_and_b32 s39, s39, 15
  s_cmp_eq_u32 s39, s4
  s_cselect_b32 s32, 512, 0
  s_mul_i32 s39, s39, 280576
  s_add_u32 s39, s39, s34
  s_add_u32 s39, s39, s32
  s_add_u32 s40, s33, 4
  s_and_b32 s40, s40, 15
  s_cmp_eq_u32 s40, s4
  s_cselect_b32 s32, 512, 0
  s_mul_i32 s40, s40, 280576
  s_add_u32 s40, s40, s34
  s_add_u32 s40, s40, s32
  s_add_u32 s41, s33, 5
  s_and_b32 s41, s41, 15
  s_cmp_eq_u32 s41, s4
  s_cselect_b32 s32, 512, 0
  s_mul_i32 s41, s41, 280576
  s_add_u32 s41, s41, s34
  s_add_u32 s41, s41, s32
  s_add_u32 s42, s33, 6
  s_and_b32 s42, s42, 15
  s_cmp_eq_u32 s42, s4
  s_cselect_b32 s32, 512, 0
  s_mul_i32 s42, s42, 280576
  s_add_u32 s42, s42, s34
  s_add_u32 s42, s42, s32
  s_add_u32 s43, s33, 7
  s_and_b32 s43, s43, 15
  s_cmp_eq_u32 s43, s4
  s_cselect_b32 s32, 512, 0
  s_mul_i32 s43, s43, 280576
  s_add_u32 s43, s43, s34
  s_add_u32 s43, s43, s32
  s_add_u32 s44, s33, 8
  s_and_b32 s44, s44, 15
  s_cmp_eq_u32 s44, s4
  s_cselect_b32 s32, 512, 0
  s_mul_i32 s44, s44, 280576
  s_add_u32 s44, s44, s34
  s_add_u32 s44, s44, s32
  s_add_u32 s45, s33, 9
  s_and_b32 s45, s45, 15
  s_cmp_eq_u32 s45, s4
  s_cselect_b32 s32, 512, 0
  s_mul_i32 s45, s45, 280576
  s_add_u32 s45, s45, s34
  s_add_u32 s45, s45, s32
  s_add_u32 s46, s33, 10
  s_and_b32 s46, s46, 15
  s_cmp_eq_u32 s46, s4
  s_cselect_b32 s32, 512, 0
  s_mul_i32 s46, s46, 280576
  s_add_u32 s46, s46, s34
  s_add_u32 s46, s46, s32
  s_add_u32 s47, s33, 11
  s_and_b32 s47, s47, 15
  s_cmp_eq_u32 s47, s4
  s_cselect_b32 s32, 512, 0
  s_mul_i32 s47, s47, 280576
  s_add_u32 s47, s47, s34
  s_add_u32 s47, s47, s32
  s_add_u32 s48, s33, 12
  s_and_b32 s48, s48, 15
  s_cmp_eq_u32 s48, s4
  s_cselect_b32 s32, 512, 0
  s_mul_i32 s48, s48, 280576
  s_add_u32 s48, s48, s34
  s_add_u32 s48, s48, s32
  s_add_u32 s49, s33, 13
  s_and_b32 s49, s49, 15
  s_cmp_eq_u32 s49, s4
  s_cselect_b32 s32, 512, 0
  s_mul_i32 s49, s49, 280576
  s_add_u32 s49, s49, s34
  s_add_u32 s49, s49, s32
  s_add_u32 s50, s33, 14
  s_and_b32 s50, s50, 15
  s_cmp_eq_u32 s50, s4
  s_cselect_b32 s32, 512, 0
  s_mul_i32 s50, s50, 280576
  s_add_u32 s50, s50, s34
  s_add_u32 s50, s50, s32
  s_add_u32 s51, s33, 15
  s_and_b32 s51, s51, 15
  s_cmp_eq_u32 s51, s4
  s_cselect_b32 s32, 512, 0
  s_mul_i32 s51, s51, 280576
  s_add_u32 s51, s51, s34
  s_add_u32 s51, s51, s32
  s_mul_i32 s34, s4, 280576
  s_add_u32 s34, s34, 20992
  s_lshl_b32 s33, s101, 2
  s_add_u32 s72, s33, 0
  s_and_b32 s72, s72, 15
  s_cmp_eq_u32 s72, s5
  s_cselect_b32 s32, 384, 0
  s_mul_i32 s72, s72, 17536
  s_add_u32 s72, s72, s34
  s_add_u32 s72, s72, s32
  s_add_u32 s73, s33, 1
  s_and_b32 s73, s73, 15
  s_cmp_eq_u32 s73, s5
  s_cselect_b32 s32, 384, 0
  s_mul_i32 s73, s73, 17536
  s_add_u32 s73, s73, s34
  s_add_u32 s73, s73, s32
  s_add_u32 s74, s33, 2
  s_and_b32 s74, s74, 15
  s_cmp_eq_u32 s74, s5
  s_cselect_b32 s32, 384, 0
  s_mul_i32 s74, s74, 17536
  s_add_u32 s74, s74, s34
  s_add_u32 s74, s74, s32
  s_add_u32 s75, s33, 3
  s_and_b32 s75, s75, 15
  s_cmp_eq_u32 s75, s5
  s_cselect_b32 s32, 384, 0
  s_mul_i32 s75, s75, 17536
  s_add_u32 s75, s75, s34
  s_add_u32 s75, s75, s32
  s_add_u32 s76, s33, 4
  s_and_b32 s76, s76, 15
  s_cmp_eq_u32 s76, s5
  s_cselect_b32 s32, 384, 0
  s_mul_i32 s76, s76, 17536
  s_add_u32 s76, s76, s34
  s_add_u32 s76, s76, s32
  s_add_u32 s77, s33, 5
  s_and_b32 s77, s77, 15
  s_cmp_eq_u32 s77, s5
  s_cselect_b32 s32, 384, 0
  s_mul_i32 s77, s77, 17536
  s_add_u32 s77, s77, s34
  s_add_u32 s77, s77, s32
  s_add_u32 s78, s33, 6
  s_and_b32 s78, s78, 15
  s_cmp_eq_u32 s78, s5
  s_cselect_b32 s32, 384, 0
  s_mul_i32 s78, s78, 17536
  s_add_u32 s78, s78, s34
  s_add_u32 s78, s78, s32
  s_add_u32 s79, s33, 7
  s_and_b32 s79, s79, 15
  s_cmp_eq_u32 s79, s5
  s_cselect_b32 s32, 384, 0
  s_mul_i32 s79, s79, 17536
  s_add_u32 s79, s79, s34
  s_add_u32 s79, s79, s32
  s_add_u32 s80, s33, 8
  s_and_b32 s80, s80, 15
  s_cmp_eq_u32 s80, s5
  s_cselect_b32 s32, 384, 0
  s_mul_i32 s80, s80, 17536
  s_add_u32 s80, s80, s34
  s_add_u32 s80, s80, s32
  s_add_u32 s81, s33, 9
  s_and_b32 s81, s81, 15
  s_cmp_eq_u32 s81, s5
  s_cselect_b32 s32, 384, 0
  s_mul_i32 s81, s81, 17536
  s_add_u32 s81, s81, s34
  s_add_u32 s81, s81, s32
  s_add_u32 s82, s33, 10
  s_and_b32 s82, s82, 15
  s_cmp_eq_u32 s82, s5
  s_cselect_b32 s32, 384, 0
  s_mul_i32 s82, s82, 17536
  s_add_u32 s82, s82, s34
  s_add_u32 s82, s82, s32
  s_add_u32 s83, s33, 11
  s_and_b32 s83, s83, 15
  s_cmp_eq_u32 s83, s5
  s_cselect_b32 s32, 384, 0
  s_mul_i32 s83, s83, 17536
  s_add_u32 s83, s83, s34
  s_add_u32 s83, s83, s32
  s_add_u32 s84, s33, 12
  s_and_b32 s84, s84, 15
  s_cmp_eq_u32 s84, s5
  s_cselect_b32 s32, 384, 0
  s_mul_i32 s84, s84, 17536
  s_add_u32 s84, s84, s34
  s_add_u32 s84, s84, s32
  s_add_u32 s85, s33, 13
  s_and_b32 s85, s85, 15
  s_cmp_eq_u32 s85, s5
  s_cselect_b32 s32, 384, 0
  s_mul_i32 s85, s85, 17536
  s_add_u32 s85, s85, s34
  s_add_u32 s85, s85, s32
  s_add_u32 s86, s33, 14
  s_and_b32 s86, s86, 15
  s_cmp_eq_u32 s86, s5
  s_cselect_b32 s32, 384, 0
  s_mul_i32 s86, s86, 17536
  s_add_u32 s86, s86, s34
  s_add_u32 s86, s86, s32
  s_add_u32 s87, s33, 15
  s_and_b32 s87, s87, 15
  s_cmp_eq_u32 s87, s5
  s_cselect_b32 s32, 384, 0
  s_mul_i32 s87, s87, 17536
  s_add_u32 s87, s87, s34
  s_add_u32 s87, s87, s32
  s_waitcnt vmcnt(0)
  v_lshl_or_b32 v32, v48, 16, v32
  ds_write_b32 v10, v32 offset:0
  v_lshl_or_b32 v33, v49, 16, v33
  ds_write_b32 v10, v33 offset:36864
  s_cmp_lg_u32 s96, 0
  s_cbranch_scc1 L_NC0
  s_swappc_b64 s[26:27], s[24:25]
L_NC0:
  s_waitcnt lgkmcnt(0)
  s_barrier
  s_mul_i32 s62, s62, 0x9E3779B1
  s_add_u32 s62, s62, 0x7F4A7C15
  s_and_b32 s62, s62, -2
  v_mov_b32 v16, s62
  ds_write_b32 v8, v16 offset:28
  s_add_u32 s31, s7, 16640
  s_waitcnt lgkmcnt(0)
  s_barrier
  s_cmp_lg_u32 s96, 1
  s_cbranch_scc1 L_NC1
  s_swappc_b64 s[26:27], s[24:25]
L_NC1:
  s_barrier
  s_cmp_lg_u32 s96, 2
  s_cbranch_scc1 L_NC2
  s_swappc_b64 s[26:27], s[24:25]
L_NC2:
  s_barrier
  s_cmp_lg_u32 s96, 3
  s_cbranch_scc1 L_NC3
  s_swappc_b64 s[26:27], s[24:25]
L_NC3:
  s_barrier
  s_cmp_lg_u32 s96, 4
  s_cbranch_scc1 L_NC4
  s_swappc_b64 s[26:27], s[24:25]
L_NC4:
  s_barrier
  s_cmp_lg_u32 s96, 5
  s_cbranch_scc1 L_NC5
  s_swappc_b64 s[26:27], s[24:25]
L_NC5:
  s_barrier
  s_cmp_lg_u32 s96, 6
  s_cbranch_scc1 L_NC6
  s_swappc_b64 s[26:27], s[24:25]
L_NC6:
  s_barrier
  s_barrier
  s_waitcnt vmcnt(0)
  s_barrier
  s_barrier
  v_mov_b32 v17, 1
  s_waitcnt vmcnt(0)
  s_mov_b64 exec, 1
W32:
  s_sleep 1
  ds_read_b32 v21, v8 offset:0
  s_sub_u32 s35, s35, 1
  s_cmp_lt_i32 s35, 0
  s_cbranch_scc1 W33
  s_waitcnt lgkmcnt(0)
  v_readfirstlane_b32 s34, v21
  s_nop 0
  s_cmp_ge_u32 s34, 1
  s_cbranch_scc0 W32
W33:
  s_waitcnt lgkmcnt(0)
  s_not_b32 s12, s62
  s_not_b32 s13, s62
  s_not_b32 s14, s62
  s_not_b32 s15, s62
  s_not_b32 s16, s62
  s_not_b32 s17, s62
  s_not_b32 s18, s62
  s_not_b32 s19, s62
  s_not_b32 s20, s62
  s_not_b32 s21, s62
  s_not_b32 s22, s62
  s_not_b32 s23, s62
  s_not_b32 s24, s62
  s_not_b32 s25, s62
  s_not_b32 s26, s62
  s_not_b32 s27, s62
  s_mov_b32 s28, 0
G34:
  s_bitcmp1_b32 s28, 0
  s_cbranch_scc1 G37
  s_buffer_load_dword s12, s[8:11], s36 glc
  s_buffer_load_dword s13, s[8:11], s37 glc
  s_buffer_load_dword s14, s[8:11], s38 glc
  s_buffer_load_dword s15, s[8:11], s39 glc
G37:
  s_bitcmp1_b32 s28, 1
  s_cbranch_scc1 G38
  s_buffer_load_dword s16, s[8:11], s40 glc
  s_buffer_load_dword s17, s[8:11], s41 glc
  s_buffer_load_dword s18, s[8:11], s42 glc
  s_buffer_load_dword s19, s[8:11], s43 glc
G38:
  s_bitcmp1_b32 s28, 2
  s_cbranch_scc1 G39
  s_buffer_load_dword s20, s[8:11], s44 glc
  s_buffer_load_dword s21, s[8:11], s45 glc
  s_buffer_load_dword s22, s[8:11], s46 glc
  s_buffer_load_dword s23, s[8:11], s47 glc
G39:
  s_bitcmp1_b32 s28, 3
  s_cbranch_scc1 G40
  s_buffer_load_dword s24, s[8:11], s48 glc
  s_buffer_load_dword s25, s[8:11], s49 glc
  s_buffer_load_dword s26, s[8:11], s50 glc
  s_buffer_load_dword s27, s[8:11], s51 glc
G40:
  s_waitcnt lgkmcnt(0)
  s_mov_b32 s29, 0
  s_xor_b32 s33, s12, s62
  s_xor_b32 s34, s13, s62
  s_or_b32 s33, s33, s34
  s_xor_b32 s34, s14, s62
  s_or_b32 s33, s33, s34
  s_xor_b32 s34, s15, s62
  s_or_b32 s33, s33, s34
  s_cselect_b32 s33, 0, 1
  s_or_b32 s29, s29, s33
  s_xor_b32 s33, s16, s62
  s_xor_b32 s34, s17, s62
  s_or_b32 s33, s33, s34
  s_xor_b32 s34, s18, s62
  s_or_b32 s33, s33, s34
  s_xor_b32 s34, s19, s62
  s_or_b32 s33, s33, s34
  s_cselect_b32 s33, 0, 2
  s_or_b32 s29, s29, s33
  s_xor_b32 s33, s20, s62
  s_xor_b32 s34, s21, s62
  s_or_b32 s33, s33, s34
  s_xor_b32 s34, s22, s62
  s_or_b32 s33, s33, s34
  s_xor_b32 s34, s23, s62
  s_or_b32 s33, s33, s34
  s_cselect_b32 s33, 0, 4
  s_or_b32 s29, s29, s33
  s_xor_b32 s33, s24, s62
  s_xor_b32 s34, s25, s62
  s_or_b32 s33, s33, s34
  s_xor_b32 s34, s26, s62
  s_or_b32 s33, s33, s34
  s_xor_b32 s34, s27, s62
  s_or_b32 s33, s33, s34
  s_cselect_b32 s33, 0, 8
  s_or_b32 s29, s29, s33
  s_sub_u32 s35, s35, 5
  s_cmp_lt_i32 s35, 0
  s_cselect_b32 s29, 15, s29
  s_or_b32 s29, s29, s28
  s_cmp_eq_u32 s29, s28
  s_cbranch_scc1 G34
  s_mov_b32 s28, s29
  v_mov_b32 v20, s29
  ds_write_b32 v8, v20 offset:4
  s_cmp_lg_u32 s28, 15
  s_cbranch_scc1 G34
  s_waitcnt lgkmcnt(0)
W41:
  s_sleep 1
  ds_read_b32 v21, v8 offset:36
  s_sub_u32 s35, s35, 1
  s_cmp_lt_i32 s35, 0
  s_cbranch_scc1 W42
  s_waitcnt lgkmcnt(0)
  v_readfirstlane_b32 s34, v21
  s_nop 0
  s_cmp_ge_u32 s34, 4
  s_cbranch_scc0 W41
W42:
  s_mov_b64 exec, -1
  s_add_u32 s30, s7, 0
  buffer_store_dwordx4 v[12:15], v2, s[8:11], s30 offen sc1
  s_add_u32 s30, s7, 1024
  buffer_store_dwordx4 v[12:15], v2, s[8:11], s30 offen sc1
  s_add_u32 s30, s7, 2048
  buffer_store_dwordx4 v[12:15], v2, s[8:11], s30 offen sc1
  s_add_u32 s30, s7, 3072
  buffer_store_dwordx4 v[12:15], v2, s[8:11], s30 offen sc1
  s_add_u32 s30, s7, 4096
  buffer_store_dwordx4 v[12:15], v2, s[8:11], s30 offen sc1
  s_add_u32 s30, s7, 5120
  buffer_store_dwordx4 v[12:15], v2, s[8:11], s30 offen sc1
  s_add_u32 s30, s7, 6144
  buffer_store_dwordx4 v[12:15], v2, s[8:11], s30 offen sc1
  s_add_u32 s30, s7, 7168
  buffer_store_dwordx4 v[12:15], v2, s[8:11], s30 offen sc1
  s_add_u32 s30, s7, 8192
  buffer_store_dwordx4 v[12:15], v2, s[8:11], s30 offen sc1
  s_add_u32 s30, s7, 9216
  buffer_store_dwordx4 v[12:15], v2, s[8:11], s30 offen sc1
  s_waitcnt vmcnt(0)
  s_mov_b64 exec, 1
  ds_add_u32 v8, v17 offset:8
W43:
  s_sleep 1
  ds_read_b32 v21, v8 offset:8
  s_sub_u32 s35, s35, 1
  s_cmp_lt_i32 s35, 0
  s_cbranch_scc1 W44
  s_waitcnt lgkmcnt(0)
  v_readfirstlane_b32 s34, v21
  s_nop 0
  s_cmp_ge_u32 s34, 4
  s_cbranch_scc0 W43
W44:
  s_waitcnt lgkmcnt(0)
  s_not_b32 s12, s62
  s_not_b32 s13, s62
  s_not_b32 s14, s62
  s_not_b32 s15, s62
  s_not_b32 s16, s62
  s_not_b32 s17, s62
  s_not_b32 s18, s62
  s_not_b32 s19, s62
  s_not_b32 s20, s62
  s_not_b32 s21, s62
  s_not_b32 s22, s62
  s_not_b32 s23, s62
  s_not_b32 s24, s62
  s_not_b32 s25, s62
  s_not_b32 s26, s62
  s_not_b32 s27, s62
  s_mov_b32 s28, 0
G45:
  s_bitcmp1_b32 s28, 0
  s_cbranch_scc1 G48
  s_buffer_load_dword s12, s[8:11], s72 glc
  s_buffer_load_dword s13, s[8:11], s73 glc
  s_buffer_load_dword s14, s[8:11], s74 glc
  s_buffer_load_dword s15, s[8:11], s75 glc
G48:
  s_bitcmp1_b32 s28, 1
  s_cbranch_scc1 G49
  s_buffer_load_dword s16, s[8:11], s76 glc
  s_buffer_load_dword s17, s[8:11], s77 glc
  s_buffer_load_dword s18, s[8:11], s78 glc
  s_buffer_load_dword s19, s[8:11], s79 glc
G49:
  s_bitcmp1_b32 s28, 2
  s_cbranch_scc1 G50
  s_buffer_load_dword s20, s[8:11], s80 glc
  s_buffer_load_dword s21, s[8:11], s81 glc
  s_buffer_load_dword s22, s[8:11], s82 glc
  s_buffer_load_dword s23, s[8:11], s83 glc
G50:
  s_bitcmp1_b32 s28, 3
  s_cbranch_scc1 G51
  s_buffer_load_dword s24, s[8:11], s84 glc
  s_buffer_load_dword s25, s[8:11], s85 glc
  s_buffer_load_dword s26, s[8:11], s86 glc
  s_buffer_load_dword s27, s[8:11], s87 glc
G51:
  s_waitcnt lgkmcnt(0)
  s_mov_b32 s29, 0
  s_xor_b32 s33, s12, s62
  s_xor_b32 s34, s13, s62
  s_or_b32 s33, s33, s34
  s_xor_b32 s34, s14, s62
  s_or_b32 s33, s33, s34
  s_xor_b32 s34, s15, s62
  s_or_b32 s33, s33, s34
  s_cselect_b32 s33, 0, 1
  s_or_b32 s29, s29, s33
  s_xor_b32 s33, s16, s62
  s_xor_b32 s34, s17, s62
  s_or_b32 s33, s33, s34
  s_xor_b32 s34, s18, s62
  s_or_b32 s33, s33, s34
  s_xor_b32 s34, s19, s62
  s_or_b32 s33, s33, s34
  s_cselect_b32 s33, 0, 2
  s_or_b32 s29, s29, s33
  s_xor_b32 s33, s20, s62
  s_xor_b32 s34, s21, s62
  s_or_b32 s33, s33, s34
  s_xor_b32 s34, s22, s62
  s_or_b32 s33, s33, s34
  s_xor_b32 s34, s23, s62
  s_or_b32 s33, s33, s34
  s_cselect_b32 s33, 0, 4
  s_or_b32 s29, s29, s33
  s_xor_b32 s33, s24, s62
  s_xor_b32 s34, s25, s62
  s_or_b32 s33, s33, s34
  s_xor_b32 s34, s26, s62
  s_or_b32 s33, s33, s34
  s_xor_b32 s34, s27, s62
  s_or_b32 s33, s33, s34
  s_cselect_b32 s33, 0, 8
  s_or_b32 s29, s29, s33
  s_sub_u32 s35, s35, 5
  s_cmp_lt_i32 s35, 0
  s_cselect_b32 s29, 15, s29
  s_or_b32 s29, s29, s28
  s_cmp_eq_u32 s29, s28
  s_cbranch_scc1 G45
  s_mov_b32 s28, s29
  v_mov_b32 v20, s29
  ds_write_b32 v8, v20 offset:12
  s_cmp_lg_u32 s28, 15
  s_cbranch_scc1 G45
  s_waitcnt lgkmcnt(0)
L_H2E:
  s_mov_b64 exec, -1
  s_endpgm
L_CLR:
  s_add_u32 s30, s7, 10240
  buffer_store_dwordx4 v[12:15], v2, s[8:11], s30 offen sc1
  s_add_u32 s30, s7, 11264
  buffer_store_dwordx4 v[12:15], v2, s[8:11], s30 offen sc1
  s_add_u32 s30, s7, 12288
  buffer_store_dwordx4 v[12:15], v2, s[8:11], s30 offen sc1
  s_add_u32 s30, s7, 13312
  buffer_store_dwordx4 v[12:15], v2, s[8:11], s30 offen sc1
  s_add_u32 s30, s7, 14336
  buffer_store_dwordx4 v[12:15], v2, s[8:11], s30 offen sc1
  s_add_u32 s30, s7, 15360
  buffer_store_dwordx4 v[12:15], v2, s[8:11], s30 offen sc1
  s_add_u32 s30, s7, 16256
  buffer_store_dwordx4 v[12:15], v2, s[8:11], s30 offen sc1
L_NCL:
  s_setpc_b64 s[26:27]
L_FFN:
  v_and_b32 v2, 15, v0
  v_lshrrev_b32 v3, 4, v0
  v_mul_u32_u24 v5, 3072, v3
  v_and_b32 v4, 7, v0
  v_lshl_add_u32 v15, v4, 4, v5
  v_lshl_add_u32 v5, v2, 4, v5
  v_mul_u32_u24 v6, 1280, v3
  v_lshl_add_u32 v6, v2, 4, v6
  v_lshrrev_b32 v7, 5, v0
  v_and_b32 v8, 31, v0
  s_mov_b32 s30, 280576
  v_mul_lo_u32 v9, v7, s30
  v_lshl_add_u32 v9, v8, 4, v9
  v_lshlrev_b32 v10, 4, v0
  v_and_b32 v11, 1, v0
  v_lshlrev_b32 v11, 4, v11
  v_mov_b32 v12, 0xffff
  v_lshlrev_b32 v11, v11, v12
  v_bfe_u32 v12, v0, 1, 2
  v_cmp_eq_u32 vcc, 0, v12
  s_nop 1
  v_cndmask_b32 v16, 0, v11, vcc
  v_cmp_eq_u32 vcc, 1, v12
  s_nop 1
  v_cndmask_b32 v17, 0, v11, vcc
  v_cmp_eq_u32 vcc, 2, v12
  s_nop 1
  v_cndmask_b32 v18, 0, v11, vcc
  v_cmp_eq_u32 vcc, 3, v12
  s_nop 1
  v_cndmask_b32 v19, 0, v11, vcc
  s_mul_i32 s62, s4, 52
  s_lshr_b32 s62, s62, 8
  s_mul_i32 s63, s62, 5
  s_sub_u32 s63, s4, s63
  v_lshrrev_b32 v11, 2, v2
  v_lshlrev_b32 v11, 9, v11
  v_and_b32 v12, 3, v2
  v_lshl_add_u32 v11, v12, 6, v11
  v_lshl_add_u32 v11, v3, 4, v11
  v_lshlrev_b32 v12, 9, v7
  v_lshl_add_u32 v12, v2, 5, v12
  v_and_b32 v14, 1, v3
  v_lshl_add_u32 v12, v14, 4, v12
  v_mov_b32 v14, 144384
  s_waitcnt lgkmcnt(0)
  s_mov_b32 s8, s48
  s_mov_b32 s9, s49
  s_mov_b32 s10, 1966080
  s_mov_b32 s11, 0x20000
  s_mov_b32 s12, s50
  s_mov_b32 s13, s51
  s_mov_b32 s14, 1966080
  s_mov_b32 s15, 0x20000
  s_mov_b32 s16, s52
  s_mov_b32 s17, s53
  s_mov_b32 s18, 1966080
  s_mov_b32 s19, 0x20000
  s_mov_b32 s20, s60
  s_mov_b32 s21, s61
  s_mov_b32 s22, 7114752
  s_mov_b32 s23, 0x20000
  s_mov_b32 s24, s36
  s_mov_b32 s25, s37
  s_mov_b32 s26, 2621440
  s_mov_b32 s27, 0x20000
  s_mul_i32 s31, s4, 122880
  s_mul_i32 s30, s5, 192
  s_add_u32 s31, s30, s31
  s_mul_i32 s32, s5, 96
  s_lshl_b32 s30, s62, 5
  s_add_u32 s32, s32, s30
  s_mul_i32 s32, s32, 1280
  s_lshl_b32 s30, s63, 8
  s_add_u32 s32, s32, s30
  s_mul_i32 s34, s5, 17536
  s_add_u32 s34, s34, 20736
  s_add_u32 s36, s4, 1
  s_and_b32 s36, s36, 15
  s_mul_i32 s36, s36, 280576
  s_add_u32 s36, s36, s34
  s_add_u32 s37, s4, 2
  s_and_b32 s37, s37, 15
  s_mul_i32 s37, s37, 280576
  s_add_u32 s37, s37, s34
  s_add_u32 s38, s4, 3
  s_and_b32 s38, s38, 15
  s_mul_i32 s38, s38, 280576
  s_add_u32 s38, s38, s34
  s_add_u32 s39, s4, 4
  s_and_b32 s39, s39, 15
  s_mul_i32 s39, s39, 280576
  s_add_u32 s39, s39, s34
  s_add_u32 s40, s4, 5
  s_and_b32 s40, s40, 15
  s_mul_i32 s40, s40, 280576
  s_add_u32 s40, s40, s34
  s_add_u32 s41, s4, 6
  s_and_b32 s41, s41, 15
  s_mul_i32 s41, s41, 280576
  s_add_u32 s41, s41, s34
  s_add_u32 s42, s4, 7
  s_and_b32 s42, s42, 15
  s_mul_i32 s42, s42, 280576
  s_add_u32 s42, s42, s34
  s_add_u32 s43, s4, 8
  s_and_b32 s43, s43, 15
  s_mul_i32 s43, s43, 280576
  s_add_u32 s43, s43, s34
  s_add_u32 s44, s4, 9
  s_and_b32 s44, s44, 15
  s_mul_i32 s44, s44, 280576
  s_add_u32 s44, s44, s34
  s_add_u32 s45, s4, 10
  s_and_b32 s45, s45, 15
  s_mul_i32 s45, s45, 280576
  s_add_u32 s45, s45, s34
  s_add_u32 s46, s4, 11
  s_and_b32 s46, s46, 15
  s_mul_i32 s46, s46, 280576
  s_add_u32 s46, s46, s34
  s_add_u32 s47, s4, 12
  s_and_b32 s47, s47, 15
  s_mul_i32 s47, s47, 280576
  s_add_u32 s47, s47, s34
  s_add_u32 s48, s4, 13
  s_and_b32 s48, s48, 15
  s_mul_i32 s48, s48, 280576
  s_add_u32 s48, s48, s34
  s_add_u32 s49, s4, 14
  s_and_b32 s49, s49, 15
  s_mul_i32 s49, s49, 280576
  s_add_u32 s49, s49, s34
  s_add_u32 s50, s4, 15
  s_and_b32 s50, s50, 15
  s_mul_i32 s50, s50, 280576
  s_add_u32 s50, s50, s34
  s_barrier
  s_barrier
  s_barrier
  s_barrier
  s_barrier
  s_barrier
  s_barrier
  s_barrier
  s_barrier
  s_barrier
  s_add_u32 s30, s31, 0
  s_mov_b32 exec_lo, 0x0fff0fff
  s_mov_b32 exec_hi, 0x0fff0fff
  buffer_load_dwordx4 v[32:35], v5, s[8:11], s30 offen
  buffer_load_dwordx4 v[36:39], v5, s[12:15], s30 offen
  s_mov_b64 exec, -1
  s_add_u32 s30, s31, 12288
  s_mov_b32 exec_lo, 0x0fff0fff
  s_mov_b32 exec_hi, 0x0fff0fff
  buffer_load_dwordx4 v[40:43], v5, s[8:11], s30 offen
  buffer_load_dwordx4 v[44:47], v5, s[12:15], s30 offen
  s_mov_b64 exec, -1
  s_add_u32 s30, s31, 24576
  s_mov_b32 exec_lo, 0x0fff0fff
  s_mov_b32 exec_hi, 0x0fff0fff
  buffer_load_dwordx4 v[48:51], v5, s[8:11], s30 offen
  buffer_load_dwordx4 v[52:55], v5, s[12:15], s30 offen
  s_mov_b64 exec, -1
  s_add_u32 s30, s31, 36864
  s_mov_b32 exec_lo, 0x0fff0fff
  s_mov_b32 exec_hi, 0x0fff0fff
  buffer_load_dwordx4 v[56:59], v5, s[8:11], s30 offen
  buffer_load_dwordx4 v[60:63], v5, s[12:15], s30 offen
  s_mov_b64 exec, -1
  s_add_u32 s30, s31, 49152
  s_mov_b32 exec_lo, 0x0fff0fff
  s_mov_b32 exec_hi, 0x0fff0fff
  buffer_load_dwordx4 v[64:67], v5, s[8:11], s30 offen
  buffer_load_dwordx4 v[68:71], v5, s[12:15], s30 offen
  s_mov_b64 exec, -1
  s_add_u32 s30, s31, 61440
  s_mov_b32 exec_lo, 0x0fff0fff
  s_mov_b32 exec_hi, 0x0fff0fff
  buffer_load_dwordx4 v[72:75], v5, s[8:11], s30 offen
  buffer_load_dwordx4 v[76:79], v5, s[12:15], s30 offen
  s_mov_b64 exec, -1
  s_add_u32 s30, s31, 73728
  s_mov_b32 exec_lo, 0x0fff0fff
  s_mov_b32 exec_hi, 0x0fff0fff
  buffer_load_dwordx4 v[80:83], v5, s[8:11], s30 offen
  buffer_load_dwordx4 v[84:87], v5, s[12:15], s30 offen
  s_mov_b64 exec, -1
  s_add_u32 s30, s31, 86016
  s_mov_b32 exec_lo, 0x0fff0fff
  s_mov_b32 exec_hi, 0x0fff0fff
  buffer_load_dwordx4 v[88:91], v5, s[8:11], s30 offen
  buffer_load_dwordx4 v[92:95], v5, s[12:15], s30 offen
  s_mov_b64 exec, -1
  s_add_u32 s30, s31, 98304
  s_mov_b32 exec_lo, 0x0fff0fff
  s_mov_b32 exec_hi, 0x0fff0fff
  buffer_load_dwordx4 v[96:99], v5, s[8:11], s30 offen
  buffer_load_dwordx4 v[100:103], v5, s[12:15], s30 offen
  s_mov_b64 exec, -1
  s_add_u32 s30, s31, 110592
  s_mov_b32 exec_lo, 0x0fff0fff
  s_mov_b32 exec_hi, 0x0fff0fff
  buffer_load_dwordx4 v[104:107], v5, s[8:11], s30 offen
  buffer_load_dwordx4 v[108:111], v5, s[12:15], s30 offen
  s_mov_b64 exec, -1
  s_add_u32 s30, s32, 0
  buffer_load_dwordx4 v[152:155], v6, s[16:19], s30 offen
  s_add_u32 s30, s32, 5120
  buffer_load_dwordx4 v[156:159], v6, s[16:19], s30 offen
  s_add_u32 s30, s32, 10240
  buffer_load_dwordx4 v[160:163], v6, s[16:19], s30 offen
  s_add_u32 s30, s32, 15360
  buffer_load_dwordx4 v[164:167], v6, s[16:19], s30 offen
  s_add_u32 s30, s32, 20480
  buffer_load_dwordx4 v[168:171], v6, s[16:19], s30 offen
  s_add_u32 s30, s32, 25600
  buffer_load_dwordx4 v[172:175], v6, s[16:19], s30 offen
  s_add_u32 s30, s32, 30720
  buffer_load_dwordx4 v[176:179], v6, s[16:19], s30 offen
  s_add_u32 s30, s32, 35840
  buffer_load_dwordx4 v[180:183], v6, s[16:19], s30 offen
  s_barrier
  s_barrier
  s_setprio 3
  ds_read_b32 v27, v14 offset:28
  v_mov_b32 v28, 1
  s_mov_b32 s30, 280576
  v_mul_lo_u32 v31, v2, s30
  v_lshlrev_b32 v24, 3, v0
  v_add_u32 v24, 143364, v24
  s_lshl_b32 s33, s4, 7
  v_add_u32 v25, s33, v0
  v_add_u32 v26, 64, v25
W52:
  s_sleep 1
  ds_read_b32 v20, v14 offset:32
  s_sub_u32 s35, s35, 1
  s_cmp_lt_i32 s35, 0
  s_cbranch_scc1 W53
  s_waitcnt lgkmcnt(0)
  v_readfirstlane_b32 s34, v20
  s_nop 0
  s_cmp_ge_u32 s34, 4
  s_cbranch_scc0 W52
W53:
  v_readfirstlane_b32 s94, v27
  ds_read_b32 v20, v24
  ds_read_b32 v21, v24 offset:512
  s_waitcnt lgkmcnt(0)
  v_ashrrev_i32 v22, 31, v20
  v_ashrrev_i32 v23, 31, v21
  v_or_b32 v22, 0x80000000, v22
  v_or_b32 v23, 0x80000000, v23
  v_xor_b32 v22, v22, v20
  v_xor_b32 v23, v23, v21
  v_or_b32 v22, 0x7ff, v22
  v_or_b32 v23, 0x7ff, v23
  v_sub_u32 v22, v22, v25
  v_sub_u32 v23, v23, v26
  v_max_u32 v20, v22, v23
  v_min_u32 v21, v22, v23
  v_mov_b32 v22, v20
  s_nop 1
  v_max_u32_dpp v22, v22, v22 quad_perm:[1,0,3,2] row_mask:0xf bank_mask:0xf
  s_nop 1
  v_max_u32_dpp v22, v22, v22 quad_perm:[2,3,0,1] row_mask:0xf bank_mask:0xf
  s_nop 1
  v_max_u32_dpp v22, v22, v22 row_half_mirror row_mask:0xf bank_mask:0xf
  s_nop 1
  v_max_u32_dpp v22, v22, v22 row_mirror row_mask:0xf bank_mask:0xf
  s_nop 0
  v_readlane_b32 s28, v22, 0
  v_readlane_b32 s30, v22, 16
  v_readlane_b32 s31, v22, 32
  v_readlane_b32 s34, v22, 48
  s_max_u32 s28, s28, s30
  s_max_u32 s31, s31, s34
  s_max_u32 s28, s28, s31
  v_cmp_eq_u32 vcc, s28, v20
  s_nop 1
  v_cndmask_b32 v22, v20, v21, vcc
  s_nop 1
  v_max_u32_dpp v22, v22, v22 quad_perm:[1,0,3,2] row_mask:0xf bank_mask:0xf
  s_nop 1
  v_max_u32_dpp v22, v22, v22 quad_perm:[2,3,0,1] row_mask:0xf bank_mask:0xf
  s_nop 1
  v_max_u32_dpp v22, v22, v22 row_half_mirror row_mask:0xf bank_mask:0xf
  s_nop 1
  v_max_u32_dpp v22, v22, v22 row_mirror row_mask:0xf bank_mask:0xf
  s_nop 0
  v_readlane_b32 s29, v22, 0
  v_readlane_b32 s30, v22, 16
  v_readlane_b32 s31, v22, 32
  v_readlane_b32 s34, v22, 48
  s_max_u32 s29, s29, s30
  s_max_u32 s31, s31, s34
  s_max_u32 s29, s29, s31
  v_mov_b32 v24, s28
  v_mov_b32 v26, s29
  v_mov_b32 v25, v27
  s_add_u32 s30, s7, 17151
  s_mov_b64 exec, 1
  buffer_store_dwordx4 v[24:27], v28, s[20:23], s30 offen sc1
  s_mul_i32 s31, s5, 17536
  s_add_u32 s31, s31, 20736
  s_mov_b64 exec, 0xffff
W54:
  s_sleep 1
  ds_read_b32 v21, v14 offset:0
  s_sub_u32 s35, s35, 1
  s_cmp_lt_i32 s35, 0
  s_cbranch_scc1 W55
  s_waitcnt lgkmcnt(0)
  v_readfirstlane_b32 s34, v21
  s_nop 0
  s_cmp_ge_u32 s34, 1
  s_cbranch_scc0 W54
W55:
S56:
  s_buffer_load_dword s76, s[20:23], s36 offset:516 glc
  s_buffer_load_dword s77, s[20:23], s37 offset:516 glc
  s_buffer_load_dword s78, s[20:23], s38 offset:516 glc
  s_buffer_load_dword s79, s[20:23], s39 offset:516 glc
  s_buffer_load_dword s80, s[20:23], s40 offset:516 glc
  s_buffer_load_dword s81, s[20:23], s41 offset:516 glc
  s_buffer_load_dword s82, s[20:23], s42 offset:516 glc
  s_buffer_load_dword s83, s[20:23], s43 offset:516 glc
  s_buffer_load_dword s84, s[20:23], s44 offset:516 glc
  s_buffer_load_dword s85, s[20:23], s45 offset:516 glc
  s_buffer_load_dword s86, s[20:23], s46 offset:516 glc
  s_buffer_load_dword s87, s[20:23], s47 offset:516 glc
  s_buffer_load_dword s88, s[20:23], s48 offset:516 glc
  s_buffer_load_dword s89, s[20:23], s49 offset:516 glc
  s_buffer_load_dword s90, s[20:23], s50 offset:516 glc
S58:
  s_sub_u32 s35, s35, 20
  s_waitcnt lgkmcnt(0)
  s_cmp_lt_i32 s35, 0
  s_cbranch_scc1 S57
  s_xor_b32 s34, s76, s94
  s_xor_b32 s77, s77, s94
  s_or_b32 s34, s34, s77
  s_xor_b32 s78, s78, s94
  s_or_b32 s34, s34, s78
  s_xor_b32 s79, s79, s94
  s_or_b32 s34, s34, s79
  s_xor_b32 s80, s80, s94
  s_or_b32 s34, s34, s80
  s_xor_b32 s81, s81, s94
  s_or_b32 s34, s34, s81
  s_xor_b32 s82, s82, s94
  s_or_b32 s34, s34, s82
  s_xor_b32 s83, s83, s94
  s_or_b32 s34, s34, s83
  s_xor_b32 s84, s84, s94
  s_or_b32 s34, s34, s84
  s_xor_b32 s85, s85, s94
  s_or_b32 s34, s34, s85
  s_xor_b32 s86, s86, s94
  s_or_b32 s34, s34, s86
  s_xor_b32 s87, s87, s94
  s_or_b32 s34, s34, s87
  s_xor_b32 s88, s88, s94
  s_or_b32 s34, s34, s88
  s_xor_b32 s89, s89, s94
  s_or_b32 s34, s34, s89
  s_xor_b32 s90, s90, s94
  s_or_b32 s34, s34, s90
  s_cbranch_scc1 S56
S57:
L_KEY:
  buffer_load_dwordx4 v[20:23], v31, s[20:23], s31 offen offset:512 sc1
  s_waitcnt vmcnt(0)
  v_cmp_ne_u32 vcc, v27, v21
  v_cmp_ne_u32 s[32:33], v27, v23
  s_nop 0
  s_or_b64 vcc, vcc, s[32:33]
  s_cbranch_vccz L_KEYOK
  s_sleep 1
  s_sub_u32 s35, s35, 20
  s_cmp_lt_i32 s35, 0
  s_cbranch_scc0 L_KEY
L_KEYOK:
  v_mov_b32 v21, v22
  v_mov_b32 v22, v20
  s_nop 1
  v_max_u32_dpp v22, v22, v22 quad_perm:[1,0,3,2] row_mask:0xf bank_mask:0xf
  s_nop 1
  v_max_u32_dpp v22, v22, v22 quad_perm:[2,3,0,1] row_mask:0xf bank_mask:0xf
  s_nop 1
  v_max_u32_dpp v22, v22, v22 row_half_mirror row_mask:0xf bank_mask:0xf
  s_nop 1
  v_max_u32_dpp v22, v22, v22 row_mirror row_mask:0xf bank_mask:0xf
  s_nop 0
  v_readlane_b32 s28, v22, 0
  s_nop 1
  v_cmp_eq_u32 vcc, s28, v20
  s_nop 1
  v_cndmask_b32 v22, v20, v21, vcc
  s_nop 1
  v_max_u32_dpp v22, v22, v22 quad_perm:[1,0,3,2] row_mask:0xf bank_mask:0xf
  s_nop 1
  v_max_u32_dpp v22, v22, v22 quad_perm:[2,3,0,1] row_mask:0xf bank_mask:0xf
  s_nop 1
  v_max_u32_dpp v22, v22, v22 row_half_mirror row_mask:0xf bank_mask:0xf
  s_nop 1
  v_max_u32_dpp v22, v22, v22 row_mirror row_mask:0xf bank_mask:0xf
  s_nop 0
  v_readlane_b32 s29, v22, 0
  s_mov_b64 exec, -1
  s_andn2_b32 s32, 0x7ff, s28
  s_andn2_b32 s33, 0x7ff, s29
  s_mul_i32 s34, s4, 80
  s_mul_i32 s30, s32, 1280
  s_mul_i32 s31, s33, 1280
  s_add_u32 s30, s30, s34
  s_add_u32 s31, s31, s34
  s_buffer_load_dwordx16 s[36:51], s[24:27], s30
  s_buffer_load_dwordx16 s[76:91], s[24:27], s31
  s_add_u32 s30, s30, 64
  s_add_u32 s31, s31, 64
  s_buffer_load_dwordx4 s[52:55], s[24:27], s30
  s_buffer_load_dwordx4 s[56:59], s[24:27], s31
  s_lshl_b32 s30, s4, 1
  s_lshr_b32 s31, s5, 3
  s_add_u32 s30, s30, s31
  s_lshr_b32 s31, s32, 6
  s_and_b32 s96, s32, 63
  s_cmp_eq_u32 s31, s30
  s_cselect_b32 s96, s96, 0xffff
  s_lshr_b32 s31, s33, 6
  s_and_b32 s97, s33, 63
  s_cmp_eq_u32 s31, s30
  s_cselect_b32 s97, s97, 0xffff
  v_mov_b32 v28, 1
  v_mov_b32 v29, s96
  v_mov_b32 v30, s97
  s_and_b32 s30, s96, s97
  s_cmp_lg_u32 s30, 0xffff
  s_cbranch_scc1 L_OWN
  ds_write_b96 v14, v[28:30] offset:16
L_OWN:
  v_and_b32 v20, 1, v3
  v_mul_u32_u24 v20, 0x0202, v20
  v_add_u32 v20, 0x0100, v20
  v_lshl_or_b32 v20, v20, 16, v20
  s_add_u32 s30, s7, 17023
  s_mov_b64 exec, 1
  buffer_store_dword v27, v28, s[20:23], s30 offen sc1
  s_waitcnt lgkmcnt(0)
  s_mov_b32 exec_lo, 16711935
  s_mov_b32 exec_hi, 0
  v_mov_b32 v216, s36
  v_mov_b32 v217, s38
  v_mov_b32 v218, s40
  v_mov_b32 v219, s42
  v_mov_b32 v220, s44
  v_mov_b32 v221, s46
  v_mov_b32 v222, s48
  v_mov_b32 v223, s50
  v_mov_b32 v224, s52
  v_mov_b32 v225, s54
  s_mov_b32 exec_lo, 4278255360
  s_mov_b32 exec_hi, 0
  v_mov_b32 v216, s76
  v_mov_b32 v217, s78
  v_mov_b32 v218, s80
  v_mov_b32 v219, s82
  v_mov_b32 v220, s84
  v_mov_b32 v221, s86
  v_mov_b32 v222, s88
  v_mov_b32 v223, s90
  v_mov_b32 v224, s56
  v_mov_b32 v225, s58
  s_mov_b32 exec_lo, 0
  s_mov_b32 exec_hi, 16711935
  v_mov_b32 v216, s37
  v_mov_b32 v217, s39
  v_mov_b32 v218, s41
  v_mov_b32 v219, s43
  v_mov_b32 v220, s45
  v_mov_b32 v221, s47
  v_mov_b32 v222, s49
  v_mov_b32 v223, s51
  v_mov_b32 v224, s53
  v_mov_b32 v225, s55
  s_mov_b32 exec_lo, 0
  s_mov_b32 exec_hi, 4278255360
  v_mov_b32 v216, s77
  v_mov_b32 v217, s79
  v_mov_b32 v218, s81
  v_mov_b32 v219, s83
  v_mov_b32 v220, s85
  v_mov_b32 v221, s87
  v_mov_b32 v222, s89
  v_mov_b32 v223, s91
  v_mov_b32 v224, s57
  v_mov_b32 v225, s59
  s_mov_b64 exec, -1
  v_perm_b32 v216, v216, v216, v20
  v_and_b32 v232, v216, v16
  v_and_b32 v233, v216, v17
  v_and_b32 v234, v216, v18
  v_and_b32 v235, v216, v19
  s_nop 1
  v_mfma_f32_16x16x32_bf16 v[240:243], v[232:235], v[32:35], 0
  v_mfma_f32_16x16x32_bf16 v[244:247], v[232:235], v[36:39], 0
  v_perm_b32 v217, v217, v217, v20
  v_and_b32 v236, v217, v16
  v_and_b32 v237, v217, v17
  v_and_b32 v238, v217, v18
  v_and_b32 v239, v217, v19
  s_nop 1
  v_mfma_f32_16x16x32_bf16 v[240:243], v[236:239], v[40:43], v[240:243]
  v_mfma_f32_16x16x32_bf16 v[244:247], v[236:239], v[44:47], v[244:247]
  v_perm_b32 v218, v218, v218, v20
  v_and_b32 v232, v218, v16
  v_and_b32 v233, v218, v17
  v_and_b32 v234, v218, v18
  v_and_b32 v235, v218, v19
  s_nop 1
  v_mfma_f32_16x16x32_bf16 v[240:243], v[232:235], v[48:51], v[240:243]
  v_mfma_f32_16x16x32_bf16 v[244:247], v[232:235], v[52:55], v[244:247]
  v_perm_b32 v219, v219, v219, v20
  v_and_b32 v236, v219, v16
  v_and_b32 v237, v219, v17
  v_and_b32 v238, v219, v18
  v_and_b32 v239, v219, v19
  s_nop 1
  v_mfma_f32_16x16x32_bf16 v[240:243], v[236:239], v[56:59], v[240:243]
  v_mfma_f32_16x16x32_bf16 v[244:247], v[236:239], v[60:63], v[244:247]
  v_perm_b32 v220, v220, v220, v20
  v_and_b32 v232, v220, v16
  v_and_b32 v233, v220, v17
  v_and_b32 v234, v220, v18
  v_and_b32 v235, v220, v19
  s_nop 1
  v_mfma_f32_16x16x32_bf16 v[240:243], v[232:235], v[64:67], v[240:243]
  v_mfma_f32_16x16x32_bf16 v[244:247], v[232:235], v[68:71], v[244:247]
  v_perm_b32 v221, v221, v221, v20
  v_and_b32 v236, v221, v16
  v_and_b32 v237, v221, v17
  v_and_b32 v238, v221, v18
  v_and_b32 v239, v221, v19
  s_nop 1
  v_mfma_f32_16x16x32_bf16 v[240:243], v[236:239], v[72:75], v[240:243]
  v_mfma_f32_16x16x32_bf16 v[244:247], v[236:239], v[76:79], v[244:247]
  v_perm_b32 v222, v222, v222, v20
  v_and_b32 v232, v222, v16
  v_and_b32 v233, v222, v17
  v_and_b32 v234, v222, v18
  v_and_b32 v235, v222, v19
  s_nop 1
  v_mfma_f32_16x16x32_bf16 v[240:243], v[232:235], v[80:83], v[240:243]
  v_mfma_f32_16x16x32_bf16 v[244:247], v[232:235], v[84:87], v[244:247]
  v_perm_b32 v223, v223, v223, v20
  v_and_b32 v236, v223, v16
  v_and_b32 v237, v223, v17
  v_and_b32 v238, v223, v18
  v_and_b32 v239, v223, v19
  s_nop 1
  v_mfma_f32_16x16x32_bf16 v[240:243], v[236:239], v[88:91], v[240:243]
  v_mfma_f32_16x16x32_bf16 v[244:247], v[236:239], v[92:95], v[244:247]
  v_perm_b32 v224, v224, v224, v20
  v_and_b32 v232, v224, v16
  v_and_b32 v233, v224, v17
  v_and_b32 v234, v224, v18
  v_and_b32 v235, v224, v19
  s_nop 1
  v_mfma_f32_16x16x32_bf16 v[240:243], v[232:235], v[96:99], v[240:243]
  v_mfma_f32_16x16x32_bf16 v[244:247], v[232:235], v[100:103], v[244:247]
  v_perm_b32 v225, v225, v225, v20
  v_and_b32 v236, v225, v16
  v_and_b32 v237, v225, v17
  v_and_b32 v238, v225, v18
  v_and_b32 v239, v225, v19
  s_nop 1
  v_mfma_f32_16x16x32_bf16 v[240:243], v[236:239], v[104:107], v[240:243]
  v_mfma_f32_16x16x32_bf16 v[244:247], v[236:239], v[108:111], v[244:247]
  s_add_u32 s30, s7, 14080
  s_nop 5
  v_min_u32 v240, -2, v240
  v_min_u32 v241, -2, v241
  v_min_u32 v242, -2, v242
  v_min_u32 v243, -2, v243
  v_min_u32 v244, -2, v244
  v_min_u32 v245, -2, v245
  v_min_u32 v246, -2, v246
  v_min_u32 v247, -2, v247
  s_mov_b32 exec_lo, 0x0fff0fff
  s_mov_b32 exec_hi, 0x0fff0fff
  buffer_store_dwordx4 v[240:243], v11, s[20:23], s30 offen sc1
  buffer_store_dwordx4 v[244:247], v11, s[20:23], s30 offen offset:256 sc1
  s_mov_b64 exec, -1
  s_cmp_eq_u32 s4, 15
  s_cbranch_scc1 L_YG
  s_mul_i32 s31, s5, 17536
  s_add_u32 s30, s31, 20736
  s_mov_b64 exec, 0xffff
  s_mul_i32 s34, s5, 17536
  s_add_u32 s34, s34, 20736
  s_add_u32 s36, s4, 1
  s_and_b32 s36, s36, 15
  s_mul_i32 s36, s36, 280576
  s_add_u32 s36, s36, s34
  s_add_u32 s37, s4, 2
  s_and_b32 s37, s37, 15
  s_mul_i32 s37, s37, 280576
  s_add_u32 s37, s37, s34
  s_add_u32 s38, s4, 3
  s_and_b32 s38, s38, 15
  s_mul_i32 s38, s38, 280576
  s_add_u32 s38, s38, s34
  s_add_u32 s39, s4, 4
  s_and_b32 s39, s39, 15
  s_mul_i32 s39, s39, 280576
  s_add_u32 s39, s39, s34
  s_add_u32 s40, s4, 5
  s_and_b32 s40, s40, 15
  s_mul_i32 s40, s40, 280576
  s_add_u32 s40, s40, s34
  s_add_u32 s41, s4, 6
  s_and_b32 s41, s41, 15
  s_mul_i32 s41, s41, 280576
  s_add_u32 s41, s41, s34
  s_add_u32 s42, s4, 7
  s_and_b32 s42, s42, 15
  s_mul_i32 s42, s42, 280576
  s_add_u32 s42, s42, s34
  s_add_u32 s43, s4, 8
  s_and_b32 s43, s43, 15
  s_mul_i32 s43, s43, 280576
  s_add_u32 s43, s43, s34
  s_add_u32 s44, s4, 9
  s_and_b32 s44, s44, 15
  s_mul_i32 s44, s44, 280576
  s_add_u32 s44, s44, s34
  s_add_u32 s45, s4, 10
  s_and_b32 s45, s45, 15
  s_mul_i32 s45, s45, 280576
  s_add_u32 s45, s45, s34
  s_add_u32 s46, s4, 11
  s_and_b32 s46, s46, 15
  s_mul_i32 s46, s46, 280576
  s_add_u32 s46, s46, s34
  s_add_u32 s47, s4, 12
  s_and_b32 s47, s47, 15
  s_mul_i32 s47, s47, 280576
  s_add_u32 s47, s47, s34
  s_add_u32 s48, s4, 13
  s_and_b32 s48, s48, 15
  s_mul_i32 s48, s48, 280576
  s_add_u32 s48, s48, s34
  s_add_u32 s49, s4, 14
  s_and_b32 s49, s49, 15
  s_mul_i32 s49, s49, 280576
  s_add_u32 s49, s49, s34
  s_add_u32 s50, s4, 15
  s_and_b32 s50, s50, 15
  s_mul_i32 s50, s50, 280576
  s_add_u32 s50, s50, s34
S59:
  s_buffer_load_dword s76, s[20:23], s36 offset:384 glc
  s_buffer_load_dword s77, s[20:23], s37 offset:384 glc
  s_buffer_load_dword s78, s[20:23], s38 offset:384 glc
  s_buffer_load_dword s79, s[20:23], s39 offset:384 glc
  s_buffer_load_dword s80, s[20:23], s40 offset:384 glc
  s_buffer_load_dword s81, s[20:23], s41 offset:384 glc
  s_buffer_load_dword s82, s[20:23], s42 offset:384 glc
  s_buffer_load_dword s83, s[20:23], s43 offset:384 glc
  s_buffer_load_dword s84, s[20:23], s44 offset:384 glc
  s_buffer_load_dword s85, s[20:23], s45 offset:384 glc
  s_buffer_load_dword s86, s[20:23], s46 offset:384 glc
  s_buffer_load_dword s87, s[20:23], s47 offset:384 glc
  s_buffer_load_dword s88, s[20:23], s48 offset:384 glc
  s_buffer_load_dword s89, s[20:23], s49 offset:384 glc
  s_buffer_load_dword s90, s[20:23], s50 offset:384 glc
S61:
  s_sub_u32 s35, s35, 20
  s_waitcnt lgkmcnt(0)
  s_cmp_lt_i32 s35, 0
  s_cbranch_scc1 S60
  s_xor_b32 s34, s76, s94
  s_xor_b32 s77, s77, s94
  s_or_b32 s34, s34, s77
  s_xor_b32 s78, s78, s94
  s_or_b32 s34, s34, s78
  s_xor_b32 s79, s79, s94
  s_or_b32 s34, s34, s79
  s_xor_b32 s80, s80, s94
  s_or_b32 s34, s34, s80
  s_xor_b32 s81, s81, s94
  s_or_b32 s34, s34, s81
  s_xor_b32 s82, s82, s94
  s_or_b32 s34, s34, s82
  s_xor_b32 s83, s83, s94
  s_or_b32 s34, s34, s83
  s_xor_b32 s84, s84, s94
  s_or_b32 s34, s34, s84
  s_xor_b32 s85, s85, s94
  s_or_b32 s34, s34, s85
  s_xor_b32 s86, s86, s94
  s_or_b32 s34, s34, s86
  s_xor_b32 s87, s87, s94
  s_or_b32 s34, s34, s87
  s_xor_b32 s88, s88, s94
  s_or_b32 s34, s34, s88
  s_xor_b32 s89, s89, s94
  s_or_b32 s34, s34, s89
  s_xor_b32 s90, s90, s94
  s_or_b32 s34, s34, s90
  s_cbranch_scc1 S59
S60:
  s_mov_b64 exec, -1
  s_lshl_b32 s30, s62, 9
  s_add_u32 s31, s31, s30
L_PG:
  s_add_u32 s30, s31, 18176
  buffer_load_dwordx4 v[32:35], v9, s[20:23], s30 offen sc1
  s_add_u32 s30, s31, 579328
  buffer_load_dwordx4 v[36:39], v9, s[20:23], s30 offen sc1
  s_add_u32 s30, s31, 1140480
  buffer_load_dwordx4 v[40:43], v9, s[20:23], s30 offen sc1
  s_add_u32 s30, s31, 1701632
  buffer_load_dwordx4 v[44:47], v9, s[20:23], s30 offen sc1
  s_add_u32 s30, s31, 2262784
  buffer_load_dwordx4 v[48:51], v9, s[20:23], s30 offen sc1
  s_add_u32 s30, s31, 2823936
  buffer_load_dwordx4 v[52:55], v9, s[20:23], s30 offen sc1
  s_add_u32 s30, s31, 3385088
  buffer_load_dwordx4 v[56:59], v9, s[20:23], s30 offen sc1
  s_add_u32 s30, s31, 3946240
  buffer_load_dwordx4 v[60:63], v9, s[20:23], s30 offen sc1
  s_waitcnt vmcnt(0)
  v_max3_u32 v20, v32, v33, v34
  v_max3_u32 v20, v20, v35, v36
  v_max3_u32 v20, v20, v37, v38
  v_max3_u32 v20, v20, v39, v40
  v_max3_u32 v20, v20, v41, v42
  v_max3_u32 v20, v20, v43, v44
  v_max3_u32 v20, v20, v45, v46
  v_max3_u32 v20, v20, v47, v48
  v_max3_u32 v20, v20, v49, v50
  v_max3_u32 v20, v20, v51, v52
  v_max3_u32 v20, v20, v53, v54
  v_max3_u32 v20, v20, v55, v56
  v_max3_u32 v20, v20, v57, v58
  v_max3_u32 v20, v20, v59, v60
  v_max3_u32 v20, v20, v61, v62
  v_max_u32 v20, v20, v63
  v_cmp_eq_u32 vcc, -1, v20
  s_cbranch_vccz L_PGOK
  s_sleep 2
  s_sub_u32 s35, s35, 50
  s_cmp_lt_i32 s35, 0
  s_cbranch_scc0 L_PG
L_PGOK:
  v_pk_add_f32 v[32:33], v[32:33], v[36:37]
  v_pk_add_f32 v[34:35], v[34:35], v[38:39]
  v_pk_add_f32 v[32:33], v[32:33], v[40:41]
  v_pk_add_f32 v[34:35], v[34:35], v[42:43]
  v_pk_add_f32 v[32:33], v[32:33], v[44:45]
  v_pk_add_f32 v[34:35], v[34:35], v[46:47]
  v_pk_add_f32 v[32:33], v[32:33], v[48:49]
  v_pk_add_f32 v[34:35], v[34:35], v[50:51]
  v_pk_add_f32 v[32:33], v[32:33], v[52:53]
  v_pk_add_f32 v[34:35], v[34:35], v[54:55]
  v_pk_add_f32 v[32:33], v[32:33], v[56:57]
  v_pk_add_f32 v[34:35], v[34:35], v[58:59]
  v_pk_add_f32 v[32:33], v[32:33], v[60:61]
  v_pk_add_f32 v[34:35], v[34:35], v[62:63]
  v_mov_b32 v36, v32
  v_mov_b32 v37, v33
  v_mov_b32 v38, v34
  v_mov_b32 v39, v35
  v_permlane32_swap_b32 v32, v36
  v_permlane32_swap_b32 v33, v37
  v_permlane32_swap_b32 v34, v38
  v_permlane32_swap_b32 v35, v39
  v_add_f32 v32, v32, v36
  v_add_f32 v33, v33, v37
  v_add_f32 v34, v34, v38
  v_add_f32 v35, v35, v39
  v_cvt_pk_bf16_f32 v32, v32, v32
  v_cvt_pk_bf16_f32 v33, v33, v33
  v_cvt_pk_bf16_f32 v34, v34, v34
  v_cvt_pk_bf16_f32 v35, v35, v35
  v_and_b32 v32, 0xffff0000, v32
  v_and_b32 v33, 0xffff0000, v33
  v_and_b32 v34, 0xffff0000, v34
  v_and_b32 v35, 0xffff0000, v35
  v_mov_b32 v36, v32
  v_mov_b32 v37, v33
  v_mov_b32 v38, v34
  v_mov_b32 v39, v35
  v_permlane16_swap_b32 v32, v36
  v_permlane16_swap_b32 v33, v37
  v_permlane16_swap_b32 v34, v38
  v_permlane16_swap_b32 v35, v39
  v_mul_f32 v40, 3216550459, v32
  v_mul_f32 v41, 3216550459, v33
  v_mul_f32 v42, 3216550459, v34
  v_mul_f32 v43, 3216550459, v35
  v_exp_f32 v40, v40
  v_exp_f32 v41, v41
  v_exp_f32 v42, v42
  v_exp_f32 v43, v43
  v_add_f32 v40, 1.0, v40
  v_add_f32 v41, 1.0, v41
  v_add_f32 v42, 1.0, v42
  v_add_f32 v43, 1.0, v43
  v_rcp_f32 v40, v40
  v_rcp_f32 v41, v41
  v_rcp_f32 v42, v42
  v_rcp_f32 v43, v43
  v_mul_f32 v40, v40, v32
  v_mul_f32 v41, v41, v33
  v_mul_f32 v42, v42, v34
  v_mul_f32 v43, v43, v35
  v_cvt_pk_bf16_f32 v40, v40, v40
  v_cvt_pk_bf16_f32 v41, v41, v41
  v_cvt_pk_bf16_f32 v42, v42, v42
  v_cvt_pk_bf16_f32 v43, v43, v43
  v_and_b32 v40, 0xffff0000, v40
  v_and_b32 v41, 0xffff0000, v41
  v_and_b32 v42, 0xffff0000, v42
  v_and_b32 v43, 0xffff0000, v43
  v_mul_f32 v40, v40, v36
  v_mul_f32 v41, v41, v37
  v_mul_f32 v42, v42, v38
  v_mul_f32 v43, v43, v39
  v_cvt_pk_bf16_f32 v40, v40, v40
  v_cvt_pk_bf16_f32 v41, v41, v41
  v_cvt_pk_bf16_f32 v42, v42, v42
  v_cvt_pk_bf16_f32 v43, v43, v43
  v_bfe_u32 v20, v0, 1, 1
  v_lshlrev_b32 v20, 7, v20
  v_bfe_u32 v21, v0, 2, 2
  v_lshl_add_u32 v20, v21, 5, v20
  v_and_b32 v21, 1, v0
  v_lshl_add_u32 v20, v21, 4, v20
  v_add_u32 v20, 144448, v20
  ds_write_b128 v20, v[40:43]
  v_bfe_u32 v21, v0, 3, 1
  v_lshlrev_b32 v21, 7, v21
  v_lshl_add_u32 v21, v3, 2, v21
  v_add_u32 v21, 144448, v21
  ds_read_b32 v216, v21 offset:0
  ds_read_b32 v217, v21 offset:16
  ds_read_b32 v218, v21 offset:32
  ds_read_b32 v219, v21 offset:48
  ds_read_b32 v220, v21 offset:64
  ds_read_b32 v221, v21 offset:80
  ds_read_b32 v222, v21 offset:96
  ds_read_b32 v223, v21 offset:112
  s_waitcnt lgkmcnt(7)
  v_and_b32 v232, v216, v16
  v_and_b32 v233, v216, v17
  v_and_b32 v234, v216, v18
  v_and_b32 v235, v216, v19
  s_nop 1
  v_mfma_f32_16x16x32_bf16 v[240:243], v[232:235], v[152:155], 0
  s_waitcnt lgkmcnt(6)
  v_and_b32 v236, v217, v16
  v_and_b32 v237, v217, v17
  v_and_b32 v238, v217, v18
  v_and_b32 v239, v217, v19
  s_nop 1
  v_mfma_f32_16x16x32_bf16 v[240:243], v[236:239], v[156:159], v[240:243]
  s_waitcnt lgkmcnt(5)
  v_and_b32 v232, v218, v16
  v_and_b32 v233, v218, v17
  v_and_b32 v234, v218, v18
  v_and_b32 v235, v218, v19
  s_nop 1
  v_mfma_f32_16x16x32_bf16 v[240:243], v[232:235], v[160:163], v[240:243]
  s_waitcnt lgkmcnt(4)
  v_and_b32 v236, v219, v16
  v_and_b32 v237, v219, v17
  v_and_b32 v238, v219, v18
  v_and_b32 v239, v219, v19
  s_nop 1
  v_mfma_f32_16x16x32_bf16 v[240:243], v[236:239], v[164:167], v[240:243]
  s_waitcnt lgkmcnt(3)
  v_and_b32 v232, v220, v16
  v_and_b32 v233, v220, v17
  v_and_b32 v234, v220, v18
  v_and_b32 v235, v220, v19
  s_nop 1
  v_mfma_f32_16x16x32_bf16 v[240:243], v[232:235], v[168:171], v[240:243]
  s_waitcnt lgkmcnt(2)
  v_and_b32 v236, v221, v16
  v_and_b32 v237, v221, v17
  v_and_b32 v238, v221, v18
  v_and_b32 v239, v221, v19
  s_nop 1
  v_mfma_f32_16x16x32_bf16 v[240:243], v[236:239], v[172:175], v[240:243]
  s_waitcnt lgkmcnt(1)
  v_and_b32 v232, v222, v16
  v_and_b32 v233, v222, v17
  v_and_b32 v234, v222, v18
  v_and_b32 v235, v222, v19
  s_nop 1
  v_mfma_f32_16x16x32_bf16 v[240:243], v[232:235], v[176:179], v[240:243]
  s_waitcnt lgkmcnt(0)
  v_and_b32 v236, v223, v16
  v_and_b32 v237, v223, v17
  v_and_b32 v238, v223, v18
  v_and_b32 v239, v223, v19
  s_nop 1
  v_mfma_f32_16x16x32_bf16 v[240:243], v[236:239], v[180:183], v[240:243]
  s_add_u32 s30, s7, 15616
  s_nop 6
  v_min_u32 v240, -2, v240
  v_min_u32 v241, -2, v241
  v_min_u32 v242, -2, v242
  v_min_u32 v243, -2, v243
  buffer_store_dwordx4 v[240:243], v12, s[20:23], s30 offen sc1
L_YG:
  s_and_b32 s30, s96, s97
  s_cmp_eq_u32 s30, 0xffff
  s_cbranch_scc1 L_FEND
  v_mul_u32_u24 v20, 3277, v0
  v_lshrrev_b32 v20, 16, v20
  v_mul_u32_u24 v21, 20, v20
  v_sub_u32 v21, v0, v21
  v_min_u32 v20, 2, v20
  s_mul_i32 s30, s100, 80
  v_lshl_add_u32 v22, v21, 2, s30
  v_lshrrev_b32 v23, 7, v22
  v_mad_u32_u24 v23, v20, 5, v23
  s_mov_b32 s30, 280576
  v_mul_lo_u32 v23, v23, s30
  v_and_b32 v22, 127, v22
  v_lshl_add_u32 v22, v22, 2, v23
  v_mul_u32_u24 v23, 320, v20
  v_lshl_add_u32 v23, v21, 4, v23
  v_add_u32 v23, 144960, v23
  v_lshlrev_b32 v24, 4, v21
  v_add_u32 v24, 144960, v24
  s_mov_b32 s98, 0
W62:
  s_sleep 1
  ds_read_b32 v25, v14 offset:12
  s_sub_u32 s35, s35, 1
  s_cmp_lt_i32 s35, 0
  s_cbranch_scc1 W63
  s_waitcnt lgkmcnt(0)
  v_readfirstlane_b32 s34, v25
  s_nop 0
  s_cmp_ge_u32 s34, 15
  s_cbranch_scc0 W62
W63:
L_YT:
  s_cmp_eq_u32 s98, 0
  s_cselect_b32 s30, s96, s97
  s_cselect_b32 s99, s28, s29
  s_cmp_eq_u32 s30, 0xffff
  s_cbranch_scc1 L_YN
  s_lshl_b32 s31, s98, 9
L_YL:
  s_add_u32 s30, s31, 19712
  buffer_load_dwordx4 v[32:35], v22, s[20:23], s30 offen sc1
  s_add_u32 s30, s31, 37248
  buffer_load_dwordx4 v[36:39], v22, s[20:23], s30 offen sc1
  s_add_u32 s30, s31, 54784
  buffer_load_dwordx4 v[40:43], v22, s[20:23], s30 offen sc1
  s_add_u32 s30, s31, 72320
  buffer_load_dwordx4 v[44:47], v22, s[20:23], s30 offen sc1
  s_add_u32 s30, s31, 89856
  buffer_load_dwordx4 v[48:51], v22, s[20:23], s30 offen sc1
  s_add_u32 s30, s31, 107392
  buffer_load_dwordx4 v[52:55], v22, s[20:23], s30 offen sc1
  s_add_u32 s30, s31, 124928
  buffer_load_dwordx4 v[56:59], v22, s[20:23], s30 offen sc1
  s_add_u32 s30, s31, 142464
  buffer_load_dwordx4 v[60:63], v22, s[20:23], s30 offen sc1
  s_add_u32 s30, s31, 160000
  buffer_load_dwordx4 v[64:67], v22, s[20:23], s30 offen sc1
  s_add_u32 s30, s31, 177536
  buffer_load_dwordx4 v[68:71], v22, s[20:23], s30 offen sc1
  s_add_u32 s30, s31, 195072
  buffer_load_dwordx4 v[72:75], v22, s[20:23], s30 offen sc1
  s_add_u32 s30, s31, 212608
  buffer_load_dwordx4 v[76:79], v22, s[20:23], s30 offen sc1
  s_add_u32 s30, s31, 230144
  buffer_load_dwordx4 v[80:83], v22, s[20:23], s30 offen sc1
  s_add_u32 s30, s31, 247680
  buffer_load_dwordx4 v[84:87], v22, s[20:23], s30 offen sc1
  s_add_u32 s30, s31, 265216
  buffer_load_dwordx4 v[88:91], v22, s[20:23], s30 offen sc1
  s_add_u32 s30, s31, 282752
  buffer_load_dwordx4 v[92:95], v22, s[20:23], s30 offen sc1
  s_waitcnt vmcnt(0)
  v_max3_u32 v25, v32, v33, v34
  v_max3_u32 v25, v25, v35, v36
  v_max3_u32 v25, v25, v37, v38
  v_max3_u32 v25, v25, v39, v40
  v_max3_u32 v25, v25, v41, v42
  v_max3_u32 v25, v25, v43, v44
  v_max3_u32 v25, v25, v45, v46
  v_max3_u32 v25, v25, v47, v48
  v_max3_u32 v25, v25, v49, v50
  v_max3_u32 v25, v25, v51, v52
  v_max3_u32 v25, v25, v53, v54
  v_max3_u32 v25, v25, v55, v56
  v_max3_u32 v25, v25, v57, v58
  v_max3_u32 v25, v25, v59, v60
  v_max3_u32 v25, v25, v61, v62
  v_max3_u32 v25, v25, v63, v64
  v_max3_u32 v25, v25, v65, v66
  v_max3_u32 v25, v25, v67, v68
  v_max3_u32 v25, v25, v69, v70
  v_max3_u32 v25, v25, v71, v72
  v_max3_u32 v25, v25, v73, v74
  v_max3_u32 v25, v25, v75, v76
  v_max3_u32 v25, v25, v77, v78
  v_max3_u32 v25, v25, v79, v80
  v_max3_u32 v25, v25, v81, v82
  v_max3_u32 v25, v25, v83, v84
  v_max3_u32 v25, v25, v85, v86
  v_max3_u32 v25, v25, v87, v88
  v_max3_u32 v25, v25, v89, v90
  v_max3_u32 v25, v25, v91, v92
  v_max3_u32 v25, v25, v93, v94
  v_max_u32 v25, v25, v95
  v_cmp_eq_u32 vcc, -1, v25
  s_cbranch_vccz L_YOK
  s_sleep 6
  s_sub_u32 s35, s35, 50
  s_cmp_lt_i32 s35, 0
  s_cbranch_scc0 L_YL
L_YOK:
  v_pk_add_f32 v[32:33], v[32:33], v[36:37]
  v_pk_add_f32 v[34:35], v[34:35], v[38:39]
  v_pk_add_f32 v[32:33], v[32:33], v[40:41]
  v_pk_add_f32 v[34:35], v[34:35], v[42:43]
  v_pk_add_f32 v[32:33], v[32:33], v[44:45]
  v_pk_add_f32 v[34:35], v[34:35], v[46:47]
  v_pk_add_f32 v[32:33], v[32:33], v[48:49]
  v_pk_add_f32 v[34:35], v[34:35], v[50:51]
  v_pk_add_f32 v[32:33], v[32:33], v[52:53]
  v_pk_add_f32 v[34:35], v[34:35], v[54:55]
  v_pk_add_f32 v[32:33], v[32:33], v[56:57]
  v_pk_add_f32 v[34:35], v[34:35], v[58:59]
  v_pk_add_f32 v[32:33], v[32:33], v[60:61]
  v_pk_add_f32 v[34:35], v[34:35], v[62:63]
  v_pk_add_f32 v[32:33], v[32:33], v[64:65]
  v_pk_add_f32 v[34:35], v[34:35], v[66:67]
  v_pk_add_f32 v[32:33], v[32:33], v[68:69]
  v_pk_add_f32 v[34:35], v[34:35], v[70:71]
  v_pk_add_f32 v[32:33], v[32:33], v[72:73]
  v_pk_add_f32 v[34:35], v[34:35], v[74:75]
  v_pk_add_f32 v[32:33], v[32:33], v[76:77]
  v_pk_add_f32 v[34:35], v[34:35], v[78:79]
  v_pk_add_f32 v[32:33], v[32:33], v[80:81]
  v_pk_add_f32 v[34:35], v[34:35], v[82:83]
  v_pk_add_f32 v[32:33], v[32:33], v[84:85]
  v_pk_add_f32 v[34:35], v[34:35], v[86:87]
  v_pk_add_f32 v[32:33], v[32:33], v[88:89]
  v_pk_add_f32 v[34:35], v[34:35], v[90:91]
  v_pk_add_f32 v[32:33], v[32:33], v[92:93]
  v_pk_add_f32 v[34:35], v[34:35], v[94:95]
  ds_write_b128 v23, v[32:35]
  ds_read_b128 v[36:39], v24
  ds_read_b128 v[40:43], v24 offset:320
  ds_read_b128 v[44:47], v24 offset:640
  s_andn2_b32 s30, s99, 0x7ff
  s_or_b32 s30, s30, 0x400
  s_ashr_i32 s31, s30, 31
  s_not_b32 s31, s31
  s_or_b32 s31, s31, 0x80000000
  s_xor_b32 s30, s30, s31
  v_mov_b32 v25, s30
  v_cvt_pk_bf16_f32 v25, v25, v25
  v_and_b32 v25, 0xffff0000, v25
  v_mul_f32 v25, 3216550459, v25
  v_exp_f32 v25, v25
  s_nop 0
  v_add_f32 v25, 1.0, v25
  v_rcp_f32 v25, v25
  s_nop 0
  v_cvt_pk_bf16_f32 v25, v25, v25
  v_and_b32 v25, 0xffff0000, v25
  s_mul_i32 s30, s98, 320
  v_add_u32 v26, s30, v24
  s_waitcnt lgkmcnt(0)
  v_add_f32 v36, v36, v40
  v_add_f32 v37, v37, v41
  v_add_f32 v38, v38, v42
  v_add_f32 v39, v39, v43
  v_add_f32 v36, v36, v44
  v_add_f32 v37, v37, v45
  v_add_f32 v38, v38, v46
  v_add_f32 v39, v39, v47
  v_cvt_pk_bf16_f32 v36, v36, v36
  v_cvt_pk_bf16_f32 v37, v37, v37
  v_cvt_pk_bf16_f32 v38, v38, v38
  v_cvt_pk_bf16_f32 v39, v39, v39
  v_and_b32 v36, 0xffff0000, v36
  v_and_b32 v37, 0xffff0000, v37
  v_and_b32 v38, 0xffff0000, v38
  v_and_b32 v39, 0xffff0000, v39
  v_mul_f32 v36, v36, v25
  v_mul_f32 v37, v37, v25
  v_mul_f32 v38, v38, v25
  v_mul_f32 v39, v39, v25
  ds_write_b128 v26, v[36:39] offset:960
  s_waitcnt lgkmcnt(0)
L_YN:
  s_add_u32 s98, s98, 1
  s_cmp_lt_u32 s98, 2
  s_cbranch_scc1 L_YT
  ds_write_b96 v14, v[28:30] offset:16
L_FEND:
  s_endpgm
L_CODE_END:
.section .rodata,"a"
.p2align 6
.amdhsa_kernel gated_mix__linear_kernel_hedgehog__moe_arch_mod__prompt_kernel
  .amdhsa_next_free_vgpr 256
  .amdhsa_next_free_sgpr 102
  .amdhsa_accum_offset 256
  .amdhsa_group_segment_fixed_size 0
  .amdhsa_kernarg_size 104
  .amdhsa_user_sgpr_count 2
  .amdhsa_user_sgpr_kernarg_segment_ptr 1
  .amdhsa_system_sgpr_workgroup_id_x 1
.end_amdhsa_kernel
```
